```python
import torch

def _softmax(x, axis=-1):
    return torch.softmax(x, dim=axis)

def _gelu(x):
    return torch.nn.functional.gelu(x, approximate='tanh')

def _silu(x):
    return torch.nn.functional.silu(x)

def _sigmoid(x):
    return torch.sigmoid(x)

def _layernorm(x, axis=-1, eps=1e-05):
    m = x.mean(dim=axis, keepdim=True)
    v = x.var(dim=axis, keepdim=True, unbiased=False)
    return (x - m) / torch.sqrt(v + eps)

def _scatter_add(tgt, idx, src, axis=0):
    return tgt.clone().index_add_(axis, idx, src)

def _segment_sum(src, seg, n):
    out = torch.zeros((n,) + src.shape[1:], dtype=src.dtype)
    return out.index_add_(0, seg, src)

def _pad(x, pw):
    flat = tuple((v for pair in reversed(pw) for v in pair))
    return torch.nn.functional.pad(x, flat)
kernel_name = 'standalone__tree_speculative_verify_tree_attention_over_candidate_token_tree__sampling'

def setup_inputs():

    _w = lambda a: (lambda t: t.to(torch.bfloat16) if t.is_floating_point() else t)(torch.as_tensor(a))
    B, Hq, Hkv, T, C, D = (8, 32, 4, 32, 8192, 128)
    tree_mask = torch.zeros((B, T, T), dtype=float)
    for b in range(B):
        parent = torch.zeros(T, dtype=torch.int64)
        for i in range(1, T):
            parent[i] = int(torch.randint(0, i, (1,)).item())
        for i in range(T):
            j = i
            tree_mask[b, i, j] = 1.0
            while j > 0:
                j = parent[j]
                tree_mask[b, i, j] = 1.0
    return {'q': _w((lambda *s: torch.randn(*s, dtype=torch.bfloat16) * 0.8)(B, Hq, T, D)), 'k_cache': _w((lambda *s: torch.randn(*s, dtype=torch.bfloat16) * 0.8)(B, Hkv, C, D)), 'v_cache': _w((lambda *s: torch.randn(*s, dtype=torch.bfloat16) * 0.05)(B, Hkv, C, D)), 'k_tree': _w((lambda *s: torch.randn(*s, dtype=torch.bfloat16) * 0.8)(B, Hkv, T, D)), 'v_tree': _w((lambda *s: torch.randn(*s, dtype=torch.bfloat16) * 0.05)(B, Hkv, T, D)), 'tree_mask': _w(tree_mask)}

def reference(q, k_cache, v_cache, k_tree, v_tree, tree_mask):
    B, Hq, T, D = q.shape
    Hkv, C = (k_cache.shape[1], k_cache.shape[2])
    rep = Hq // Hkv
    kc = (lambda x, n, axis: torch.repeat_interleave(x, n, dim=axis))(k_cache, rep, axis=1)
    vc = (lambda x, n, axis: torch.repeat_interleave(x, n, dim=axis))(v_cache, rep, axis=1)
    kt = (lambda x, n, axis: torch.repeat_interleave(x, n, dim=axis))(k_tree, rep, axis=1)
    vt = (lambda x, n, axis: torch.repeat_interleave(x, n, dim=axis))(v_tree, rep, axis=1)
    k = torch.concatenate([kc, kt], axis=2)
    v = torch.concatenate([vc, vt], axis=2)
    scale = D ** (-0.5)
    scores = torch.einsum('bhqd,bhkd->bhqk', q, k) * scale
    ctx_mask = torch.ones((B, 1, T, C), dtype=scores.dtype)
    tm = tree_mask[:, None, :, :].clone()
    full_mask = torch.concatenate([ctx_mask, tm], axis=-1)
    scores = scores + (1.0 - full_mask) * -1000000000.0
    p = _softmax(scores, axis=-1)
    return torch.einsum('bhqk,bhkd->bhqd', p, v)
```

```asm
; @launch grid=(256,1,1) block=(512,1,1) lds=155712
.amdgcn_target "amdgcn-amd-amdhsa--gfx950"
.text
.globl standalone__tree_speculative_verify_tree_attention_over_candidate_token_tree__sampling_kernel
.p2align 8
.type standalone__tree_speculative_verify_tree_attention_over_candidate_token_tree__sampling_kernel,@function
standalone__tree_speculative_verify_tree_attention_over_candidate_token_tree__sampling_kernel:
    s_cmp_ge_u32 s2, 256
    s_cbranch_scc1 DONE
    s_load_dwordx16 s[4:19], s[0:1], 0
    s_load_dwordx2 s[20:21], s[0:1], 64
    s_and_b32 s22, s2, 31
    s_lshr_b32 s23, s2, 5
    v_lshrrev_b32 v250, 6, v0
    v_and_b32 v249, 63, v0
    v_readfirstlane_b32 s24, v250
    v_bfe_u32 v250, v0, 4, 4
    v_and_b32 v251, 15, v0
    v_xor_b32 v252, v250, v251
    v_lshlrev_b32 v252, 4, v252
    v_lshl_add_u32 v240, v250, 8, v252
    v_and_b32 v252, 7, v250
    v_lshlrev_b32 v252, 1, v252
    v_xor_b32 v252, v252, v251
    v_lshlrev_b32 v252, 4, v252
    v_lshl_add_u32 v241, v250, 8, v252
    v_and_b32 v248, 255, v0
    v_lshlrev_b32 v248, 4, v248
    s_and_b32 s25, s24, 3
    s_lshl_b32 s25, s25, 10
    v_and_b32 v250, 15, v249
    v_lshrrev_b32 v251, 4, v249
    v_lshlrev_b32 v252, 4, v251
    v_lshl_add_u32 v247, v250, 8, v252
    s_lshl_b32 s28, s24, 13
    v_add_u32 v247, s28, v247
    s_lshl_b32 s28, s22, 21
    s_lshl_b32 s29, s23, 18
    s_add_u32 s28, s28, s29
    s_lshl_b32 s29, s22, 16
    s_lshl_b32 s30, s22, 13
    s_lshr_b32 s31, s22, 2
    s_lshl_b32 s31, s31, 11
    s_mov_b32 s74, 4096
    s_mov_b32 s26, 0
    s_mov_b32 s3, 4096
    s_waitcnt lgkmcnt(0)
    s_add_u32 s32, s6, s28
    s_addc_u32 s33, s7, 0
    s_and_b32 s33, s33, 0xffff
    s_mov_b32 s34, 262144
    s_mov_b32 s35, 0x00020000
    s_add_u32 s40, s4, s29
    s_addc_u32 s41, s5, 0
    s_and_b32 s41, s41, 0xffff
    s_mov_b32 s42, 65536
    s_mov_b32 s43, 0x00020000
    s_lshr_b32 s0, s24, 2
    s_lshl_b32 s73, s0, 12
    s_add_u32 s1, s25, s73
    s_lshr_b32 s3, s23, 2
    s_xor_b32 s0, s0, s3
    s_xor_b32 s96, s3, 1
    s_lshl_b32 s96, s96, 2
    s_add_u32 m0, s1, 8192
    s_add_u32 s36, s8, s28
    s_addc_u32 s37, s9, 0
    s_and_b32 s37, s37, 0xffff
    s_mov_b32 s38, 262144
    s_mov_b32 s39, 0x00020000
    buffer_load_dwordx4 v240, s[32:35], s73 offen nt lds
    s_add_u32 m0, s1, 0
    s_add_u32 s26, s73, 0
    buffer_load_dwordx4 v240, s[40:43], s26 offen lds
    s_add_u32 m0, s1, 49152
    s_add_u32 s26, s73, 8192
    buffer_load_dwordx4 v240, s[40:43], s26 offen lds
    s_add_u32 m0, s1, 57344
    s_add_u32 s26, s73, 16384
    buffer_load_dwordx4 v240, s[40:43], s26 offen lds
    s_add_u32 m0, s1, 98304
    s_add_u32 s26, s73, 24576
    buffer_load_dwordx4 v240, s[40:43], s26 offen lds
    s_add_u32 m0, s1, 106496
    s_add_u32 s26, s73, 32768
    buffer_load_dwordx4 v240, s[40:43], s26 offen lds
    s_add_u32 m0, s1, 114688
    s_add_u32 s26, s73, 40960
    buffer_load_dwordx4 v240, s[40:43], s26 offen lds
    s_add_u32 m0, s1, 122880
    s_add_u32 s26, s73, 49152
    buffer_load_dwordx4 v240, s[40:43], s26 offen lds
    s_add_u32 m0, s1, 131072
    s_add_u32 s26, s73, 57344
    buffer_load_dwordx4 v240, s[40:43], s26 offen lds
    s_add_u32 m0, s1, 65536
    s_add_u32 s26, s73, 0
    buffer_load_dwordx4 v241, s[36:39], s26 offen nt lds
    s_add_u32 m0, s1, 16384
    s_add_u32 s26, s73, 8192
    buffer_load_dwordx4 v240, s[32:35], s26 offen nt lds
    s_add_u32 s44, s10, s30
    s_addc_u32 s45, s11, 0
    s_and_b32 s45, s45, 0xffff
    s_mov_b32 s46, 8192
    s_mov_b32 s47, 0x00020000
    s_add_u32 s48, s12, s30
    s_addc_u32 s49, s13, 0
    s_and_b32 s49, s49, 0xffff
    s_mov_b32 s50, 8192
    s_mov_b32 s51, 0x00020000
    s_add_u32 s52, s14, s31
    s_addc_u32 s53, s15, 0
    s_and_b32 s53, s53, 0xffff
    s_mov_b32 s54, 2048
    s_mov_b32 s55, 0x00020000
    s_lshl_b32 s28, s22, 20
    s_add_u32 s56, s20, s28
    s_addc_u32 s57, s21, 0
    s_and_b32 s57, s57, 0xffff
    s_mov_b32 s58, 1048576
    s_mov_b32 s59, 0x00020000
    s_lshl_b32 s29, s23, 11
    s_add_u32 s29, s29, 524288
    s_add_u32 s28, s28, s29
    s_add_u32 s76, s20, s28
    s_addc_u32 s77, s21, 0
    s_and_b32 s77, s77, 0xffff
    s_mov_b32 s78, 2048
    s_mov_b32 s79, 0x00020000
    s_mov_b32 s68, s18
    s_and_b32 s69, s19, 0xffff
    s_mov_b32 s70, 256
    s_mov_b32 s71, 0x00020000
    s_lshl_b32 s75, s22, 3
    s_add_u32 s28, s75, s23
    s_lshl_b32 s28, s28, 13
    s_add_u32 s64, s16, s28
    s_addc_u32 s65, s17, 0
    s_and_b32 s65, s65, 0xffff
    s_mov_b32 s66, 8192
    s_mov_b32 s67, 0x00020000
    v_xor_b32 v252, v250, v251
    v_lshlrev_b32 v252, 4, v252
    v_lshl_add_u32 v228, v250, 8, v252
    v_xor_b32 v229, 64, v228
    v_xor_b32 v230, 128, v228
    v_xor_b32 v231, 192, v228
    v_lshrrev_b32 v250, 2, v249
    v_and_b32 v252, 7, v250
    v_lshlrev_b32 v252, 1, v252
    v_bfe_u32 v253, v249, 1, 1
    v_or_b32 v252, v252, v253
    v_lshlrev_b32 v252, 4, v252
    v_lshl_add_u32 v252, v250, 8, v252
    v_and_b32 v253, 1, v249
    v_lshl_add_u32 v252, v253, 3, v252
    v_add_u32 v232, 65536, v252
    v_xor_b32 v233, 32, v232
    v_xor_b32 v234, 64, v232
    v_xor_b32 v235, 96, v232
    v_xor_b32 v236, 128, v232
    v_xor_b32 v237, 160, v232
    v_xor_b32 v238, 192, v232
    v_xor_b32 v239, 224, v232
    v_and_b32 v253, 3, v249
    v_cmp_eq_u32 vcc, 0, v253
    v_mov_b32 v252, 0x3f803f80
    s_nop 0
    v_cndmask_b32 v224, 0, v252, vcc
    v_cndmask_b32 v225, 0, v252, vcc
    v_cndmask_b32 v226, 0, v252, vcc
    v_cndmask_b32 v227, 0, v252, vcc
    v_mov_b32 v0, 0
    v_mov_b32 v1, 0
    v_mov_b32 v2, 0
    v_mov_b32 v3, 0
    v_mov_b32 v4, 0
    v_mov_b32 v5, 0
    v_mov_b32 v6, 0
    v_mov_b32 v7, 0
    v_mov_b32 v8, 0
    v_mov_b32 v9, 0
    v_mov_b32 v10, 0
    v_mov_b32 v11, 0
    v_mov_b32 v12, 0
    v_mov_b32 v13, 0
    v_mov_b32 v14, 0
    v_mov_b32 v15, 0
    v_mov_b32 v16, 0
    v_mov_b32 v17, 0
    v_mov_b32 v18, 0
    v_mov_b32 v19, 0
    v_mov_b32 v20, 0
    v_mov_b32 v21, 0
    v_mov_b32 v22, 0
    v_mov_b32 v23, 0
    v_mov_b32 v24, 0
    v_mov_b32 v25, 0
    v_mov_b32 v26, 0
    v_mov_b32 v27, 0
    v_mov_b32 v28, 0
    v_mov_b32 v29, 0
    v_mov_b32 v30, 0
    v_mov_b32 v31, 0
    v_mov_b32 v32, 0
    v_mov_b32 v33, 0
    v_mov_b32 v34, 0
    v_mov_b32 v35, 0
    v_mov_b32 v36, 0
    v_mov_b32 v37, 0
    v_mov_b32 v38, 0
    v_mov_b32 v39, 0
    v_mov_b32 v40, 0
    v_mov_b32 v41, 0
    v_mov_b32 v42, 0
    v_mov_b32 v43, 0
    v_mov_b32 v44, 0
    v_mov_b32 v45, 0
    v_mov_b32 v46, 0
    v_mov_b32 v47, 0
    v_mov_b32 v48, 0
    v_mov_b32 v49, 0
    v_mov_b32 v50, 0
    v_mov_b32 v51, 0
    v_mov_b32 v52, 0
    v_mov_b32 v53, 0
    v_mov_b32 v54, 0
    v_mov_b32 v55, 0
    v_mov_b32 v56, 0
    v_mov_b32 v57, 0
    v_mov_b32 v58, 0
    v_mov_b32 v59, 0
    v_mov_b32 v60, 0
    v_mov_b32 v61, 0
    v_mov_b32 v62, 0
    v_mov_b32 v63, 0
    v_mov_b32 v216, 0
    v_mov_b32 v217, 0
    v_mov_b32 v218, 0
    v_mov_b32 v219, 0
    v_mov_b32 v220, 0
    v_mov_b32 v221, 0
    v_mov_b32 v222, 0
    v_mov_b32 v223, 0
    s_mov_b32 s27, 0x3e0293ee
    s_cmp_lt_u32 s24, 3
    s_cselect_b32 s28, 5, 9
    s_add_u32 s28, s28, s24
    s_lshl_b32 s28, s28, 13
    s_cmp_eq_u32 s24, 0
    s_cselect_b32 s28, 0, s28
    v_add_u32 v80, s28, v228
    v_add_u32 v81, s28, v229
    v_add_u32 v82, s28, v230
    v_add_u32 v83, s28, v231
    s_waitcnt vmcnt(2)
    s_barrier
    ds_read_b128 v[112:115], v80 offset:0
    ds_read_b128 v[116:119], v81 offset:0
    ds_read_b128 v[120:123], v82 offset:0
    ds_read_b128 v[124:127], v83 offset:0
    ds_read_b128 v[128:131], v80 offset:4096
    ds_read_b128 v[132:135], v81 offset:4096
    ds_read_b128 v[136:139], v82 offset:4096
    ds_read_b128 v[140:143], v83 offset:4096
    ds_read_b128 v[144:147], v228 offset:8192
    ds_read_b128 v[148:151], v229 offset:8192
    ds_read_b128 v[152:155], v230 offset:8192
    ds_read_b128 v[156:159], v231 offset:8192
    ds_read_b128 v[160:163], v228 offset:12288
    ds_read_b128 v[164:167], v229 offset:12288
    ds_read_b128 v[168:171], v230 offset:12288
    ds_read_b128 v[172:175], v231 offset:12288
    s_add_u32 m0, s1, 73728
    s_add_u32 s26, s73, 8192
    s_waitcnt lgkmcnt(15)
    v_lshlrev_b32 v242, 16, v112
    buffer_load_dwordx4 v241, s[36:39], s26 offen nt lds
    v_and_b32 v243, 0xffff0000, v112
    v_mul_f32 v242, s27, v242
    v_mul_f32 v243, s27, v243
    v_cvt_pk_bf16_f32 v112, v242, v243
    v_lshlrev_b32 v244, 16, v113
    v_and_b32 v245, 0xffff0000, v113
    v_mul_f32 v244, s27, v244
    v_mul_f32 v245, s27, v245
    v_cvt_pk_bf16_f32 v113, v244, v245
    v_lshlrev_b32 v246, 16, v114
    v_and_b32 v247, 0xffff0000, v114
    v_mul_f32 v246, s27, v246
    v_mul_f32 v247, s27, v247
    v_cvt_pk_bf16_f32 v114, v246, v247
    v_lshlrev_b32 v242, 16, v115
    v_and_b32 v243, 0xffff0000, v115
    v_mul_f32 v242, s27, v242
    v_mul_f32 v243, s27, v243
    v_cvt_pk_bf16_f32 v115, v242, v243
    s_waitcnt lgkmcnt(14)
    v_lshlrev_b32 v244, 16, v116
    v_and_b32 v245, 0xffff0000, v116
    v_mul_f32 v244, s27, v244
    v_mul_f32 v245, s27, v245
    v_cvt_pk_bf16_f32 v116, v244, v245
    s_add_u32 m0, s1, 24576
    s_add_u32 s26, s73, 16384
    v_lshlrev_b32 v246, 16, v117
    buffer_load_dwordx4 v240, s[32:35], s26 offen nt lds
    v_and_b32 v247, 0xffff0000, v117
    v_mul_f32 v246, s27, v246
    v_mul_f32 v247, s27, v247
    v_cvt_pk_bf16_f32 v117, v246, v247
    v_lshlrev_b32 v242, 16, v118
    v_and_b32 v243, 0xffff0000, v118
    v_mul_f32 v242, s27, v242
    v_mul_f32 v243, s27, v243
    v_cvt_pk_bf16_f32 v118, v242, v243
    v_lshlrev_b32 v244, 16, v119
    v_and_b32 v245, 0xffff0000, v119
    v_mul_f32 v244, s27, v244
    v_mul_f32 v245, s27, v245
    v_cvt_pk_bf16_f32 v119, v244, v245
    s_waitcnt lgkmcnt(13)
    v_lshlrev_b32 v246, 16, v120
    v_and_b32 v247, 0xffff0000, v120
    v_mul_f32 v246, s27, v246
    v_mul_f32 v247, s27, v247
    v_cvt_pk_bf16_f32 v120, v246, v247
    v_lshlrev_b32 v242, 16, v121
    v_and_b32 v243, 0xffff0000, v121
    v_mul_f32 v242, s27, v242
    v_mul_f32 v243, s27, v243
    v_cvt_pk_bf16_f32 v121, v242, v243
    v_lshlrev_b32 v244, 16, v122
    v_and_b32 v245, 0xffff0000, v122
    v_mul_f32 v244, s27, v244
    v_mul_f32 v245, s27, v245
    v_cvt_pk_bf16_f32 v122, v244, v245
    s_add_u32 m0, s1, 81920
    s_add_u32 s26, s73, 16384
    v_lshlrev_b32 v246, 16, v123
    buffer_load_dwordx4 v241, s[36:39], s26 offen nt lds
    v_and_b32 v247, 0xffff0000, v123
    v_mul_f32 v246, s27, v246
    v_mul_f32 v247, s27, v247
    v_cvt_pk_bf16_f32 v123, v246, v247
    s_waitcnt lgkmcnt(12)
    v_lshlrev_b32 v242, 16, v124
    v_and_b32 v243, 0xffff0000, v124
    v_mul_f32 v242, s27, v242
    v_mul_f32 v243, s27, v243
    v_cvt_pk_bf16_f32 v124, v242, v243
    v_lshlrev_b32 v244, 16, v125
    v_and_b32 v245, 0xffff0000, v125
    v_mul_f32 v244, s27, v244
    v_mul_f32 v245, s27, v245
    v_cvt_pk_bf16_f32 v125, v244, v245
    v_lshlrev_b32 v246, 16, v126
    v_and_b32 v247, 0xffff0000, v126
    v_mul_f32 v246, s27, v246
    v_mul_f32 v247, s27, v247
    v_cvt_pk_bf16_f32 v126, v246, v247
    v_lshlrev_b32 v242, 16, v127
    v_and_b32 v243, 0xffff0000, v127
    v_mul_f32 v242, s27, v242
    v_mul_f32 v243, s27, v243
    v_cvt_pk_bf16_f32 v127, v242, v243
    s_add_u32 m0, s1, 32768
    s_add_u32 s26, s73, 24576
    s_waitcnt lgkmcnt(11)
    v_lshlrev_b32 v244, 16, v128
    buffer_load_dwordx4 v240, s[32:35], s26 offen nt lds
    v_and_b32 v245, 0xffff0000, v128
    v_mul_f32 v244, s27, v244
    v_mul_f32 v245, s27, v245
    v_cvt_pk_bf16_f32 v128, v244, v245
    v_lshlrev_b32 v246, 16, v129
    v_and_b32 v247, 0xffff0000, v129
    v_mul_f32 v246, s27, v246
    v_mul_f32 v247, s27, v247
    v_cvt_pk_bf16_f32 v129, v246, v247
    s_waitcnt lgkmcnt(7)
    v_mfma_f32_16x16x32_bf16 v[64:67], v[144:147], v[112:115], 0
    v_lshlrev_b32 v242, 16, v130
    v_and_b32 v243, 0xffff0000, v130
    v_mul_f32 v242, s27, v242
    v_mul_f32 v243, s27, v243
    v_cvt_pk_bf16_f32 v130, v242, v243
    v_lshlrev_b32 v244, 16, v131
    v_and_b32 v245, 0xffff0000, v131
    v_mul_f32 v244, s27, v244
    v_mul_f32 v245, s27, v245
    v_cvt_pk_bf16_f32 v131, v244, v245
    s_waitcnt lgkmcnt(6)
    v_mfma_f32_16x16x32_bf16 v[64:67], v[148:151], v[116:119], v[64:67]
    v_lshlrev_b32 v246, 16, v132
    v_and_b32 v247, 0xffff0000, v132
    v_mul_f32 v246, s27, v246
    v_mul_f32 v247, s27, v247
    v_cvt_pk_bf16_f32 v132, v246, v247
    s_add_u32 m0, s1, 90112
    s_add_u32 s26, s73, 24576
    v_lshlrev_b32 v242, 16, v133
    buffer_load_dwordx4 v241, s[36:39], s26 offen nt lds
    v_and_b32 v243, 0xffff0000, v133
    v_mul_f32 v242, s27, v242
    v_mul_f32 v243, s27, v243
    v_cvt_pk_bf16_f32 v133, v242, v243
    s_waitcnt lgkmcnt(5)
    v_mfma_f32_16x16x32_bf16 v[64:67], v[152:155], v[120:123], v[64:67]
    v_lshlrev_b32 v244, 16, v134
    v_and_b32 v245, 0xffff0000, v134
    v_mul_f32 v244, s27, v244
    v_mul_f32 v245, s27, v245
    v_cvt_pk_bf16_f32 v134, v244, v245
    v_lshlrev_b32 v246, 16, v135
    v_and_b32 v247, 0xffff0000, v135
    v_mul_f32 v246, s27, v246
    v_mul_f32 v247, s27, v247
    v_cvt_pk_bf16_f32 v135, v246, v247
    s_waitcnt lgkmcnt(4)
    v_mfma_f32_16x16x32_bf16 v[64:67], v[156:159], v[124:127], v[64:67]
    v_lshlrev_b32 v242, 16, v136
    v_and_b32 v243, 0xffff0000, v136
    v_mul_f32 v242, s27, v242
    v_mul_f32 v243, s27, v243
    v_cvt_pk_bf16_f32 v136, v242, v243
    v_lshlrev_b32 v244, 16, v137
    v_and_b32 v245, 0xffff0000, v137
    v_mul_f32 v244, s27, v244
    v_mul_f32 v245, s27, v245
    v_cvt_pk_bf16_f32 v137, v244, v245
    s_waitcnt lgkmcnt(3)
    v_mfma_f32_16x16x32_bf16 v[72:75], v[160:163], v[112:115], 0
    v_lshlrev_b32 v246, 16, v138
    v_and_b32 v247, 0xffff0000, v138
    v_mul_f32 v246, s27, v246
    v_mul_f32 v247, s27, v247
    v_cvt_pk_bf16_f32 v138, v246, v247
    s_add_u32 m0, s1, 40960
    s_add_u32 s26, s73, 32768
    v_lshlrev_b32 v242, 16, v139
    buffer_load_dwordx4 v240, s[32:35], s26 offen nt lds
    v_and_b32 v243, 0xffff0000, v139
    v_mul_f32 v242, s27, v242
    v_mul_f32 v243, s27, v243
    v_cvt_pk_bf16_f32 v139, v242, v243
    s_waitcnt lgkmcnt(2)
    v_mfma_f32_16x16x32_bf16 v[72:75], v[164:167], v[116:119], v[72:75]
    v_lshlrev_b32 v244, 16, v140
    v_and_b32 v245, 0xffff0000, v140
    v_mul_f32 v244, s27, v244
    v_mul_f32 v245, s27, v245
    v_cvt_pk_bf16_f32 v140, v244, v245
    v_lshlrev_b32 v246, 16, v141
    v_and_b32 v247, 0xffff0000, v141
    v_mul_f32 v246, s27, v246
    v_mul_f32 v247, s27, v247
    v_cvt_pk_bf16_f32 v141, v246, v247
    s_waitcnt lgkmcnt(1)
    v_mfma_f32_16x16x32_bf16 v[72:75], v[168:171], v[120:123], v[72:75]
    v_lshlrev_b32 v242, 16, v142
    v_and_b32 v243, 0xffff0000, v142
    v_mul_f32 v242, s27, v242
    v_mul_f32 v243, s27, v243
    v_cvt_pk_bf16_f32 v142, v242, v243
    v_lshlrev_b32 v244, 16, v143
    v_and_b32 v245, 0xffff0000, v143
    v_mul_f32 v244, s27, v244
    v_mul_f32 v245, s27, v245
    v_cvt_pk_bf16_f32 v143, v244, v245
    s_waitcnt lgkmcnt(0)
    v_mfma_f32_16x16x32_bf16 v[72:75], v[172:175], v[124:127], v[72:75]
    v_mfma_f32_16x16x32_bf16 v[68:71], v[144:147], v[128:131], 0
    v_mfma_f32_16x16x32_bf16 v[68:71], v[148:151], v[132:135], v[68:71]
    v_mfma_f32_16x16x32_bf16 v[68:71], v[152:155], v[136:139], v[68:71]
    v_mfma_f32_16x16x32_bf16 v[68:71], v[156:159], v[140:143], v[68:71]
    v_mfma_f32_16x16x32_bf16 v[76:79], v[160:163], v[128:131], 0
    v_mfma_f32_16x16x32_bf16 v[76:79], v[164:167], v[132:135], v[76:79]
    v_mfma_f32_16x16x32_bf16 v[76:79], v[168:171], v[136:139], v[76:79]
    v_mfma_f32_16x16x32_bf16 v[76:79], v[172:175], v[140:143], v[76:79]
    v_lshrrev_b32 v250, 4, v249
    v_and_b32 v251, 15, v249
    s_lshl_b32 s72, s25, 2
    v_xor_b32 v252, v250, v251
    v_lshlrev_b32 v252, 4, v252
    v_lshl_add_u32 v240, v250, 8, v252
    v_lshlrev_b32 v252, 1, v250
    v_xor_b32 v252, v252, v251
    v_lshlrev_b32 v252, 4, v252
    v_lshl_add_u32 v241, v250, 8, v252
    v_max3_f32 v250, v64, v65, v66
    v_max3_f32 v251, v67, v72, v73
    v_max3_f32 v250, v250, v74, v75
    v_max_f32 v250, v250, v251
    v_mov_b32 v251, v250
    s_nop 1
    v_permlane32_swap_b32 v250, v251
    v_max_f32 v250, v250, v251
    v_mov_b32 v251, v250
    s_nop 1
    v_permlane16_swap_b32 v250, v251
    v_max_f32 v250, v250, v251
    v_add_f32 v250, 0x41000000, v250
    v_sub_f32 v208, 0, v250
    v_sub_f32 v209, 0, v250
    v_sub_f32 v210, 0, v250
    v_sub_f32 v211, 0, v250
    v_sub_f32 v64, v64, v250
    v_sub_f32 v65, v65, v250
    v_sub_f32 v66, v66, v250
    v_sub_f32 v67, v67, v250
    v_sub_f32 v72, v72, v250
    v_sub_f32 v73, v73, v250
    v_sub_f32 v74, v74, v250
    v_sub_f32 v75, v75, v250
    v_max3_f32 v252, v68, v69, v70
    v_max3_f32 v253, v71, v76, v77
    v_max3_f32 v252, v252, v78, v79
    v_max_f32 v252, v252, v253
    v_mov_b32 v253, v252
    s_nop 1
    v_permlane32_swap_b32 v252, v253
    v_max_f32 v252, v252, v253
    v_mov_b32 v253, v252
    s_nop 1
    v_permlane16_swap_b32 v252, v253
    v_max_f32 v252, v252, v253
    v_add_f32 v252, 0x41000000, v252
    v_sub_f32 v212, 0, v252
    v_sub_f32 v213, 0, v252
    v_sub_f32 v214, 0, v252
    v_sub_f32 v215, 0, v252
    v_sub_f32 v68, v68, v252
    v_sub_f32 v69, v69, v252
    v_sub_f32 v70, v70, v252
    v_sub_f32 v71, v71, v252
    v_sub_f32 v76, v76, v252
    v_sub_f32 v77, v77, v252
    v_sub_f32 v78, v78, v252
    v_sub_f32 v79, v79, v252
    s_cmp_eq_u32 s0, 0
    s_cbranch_scc1 STEP_0
    s_waitcnt vmcnt(4) lgkmcnt(0)
    s_barrier
    s_waitcnt vmcnt(0) lgkmcnt(0)
    s_barrier
STEP_0:
    s_waitcnt vmcnt(4) lgkmcnt(0)
    s_barrier
    ds_read_b128 v[144:147], v228 offset:16384
    ds_read_b128 v[148:151], v229 offset:16384
    ds_read_b128 v[152:155], v230 offset:16384
    ds_read_b128 v[156:159], v231 offset:16384
    ds_read_b128 v[160:163], v228 offset:20480
    ds_read_b128 v[164:167], v229 offset:20480
    ds_read_b128 v[168:171], v230 offset:20480
    ds_read_b128 v[172:175], v231 offset:20480
    s_cmp_eq_u32 s0, 0
    s_cbranch_scc0 BU0V
    s_add_u32 m0, s72, 98304
    s_add_u32 s26, s72, 32768
    buffer_load_dwordx4 v241, s[36:39], s26 offen offset:0 nt lds
    v_xor_b32 v251, 128, v241
    buffer_load_dwordx4 v251, s[36:39], s26 offen offset:1024 nt lds
    buffer_load_dwordx4 v241, s[36:39], s26 offen offset:2048 nt lds
    v_xor_b32 v251, 128, v241
    buffer_load_dwordx4 v251, s[36:39], s26 offen offset:3072 nt lds
BU0V:
    s_waitcnt lgkmcnt(7)
    v_mfma_f32_16x16x32_bf16 v[80:83], v[144:147], v[112:115], v[208:211]
    ds_read_b64_tr_b16 v[176:177], v232 offset:0
    s_waitcnt lgkmcnt(7)
    v_mfma_f32_16x16x32_bf16 v[80:83], v[148:151], v[116:119], v[80:83]
    v_exp_f32 v242, v64
    ds_read_b64_tr_b16 v[178:179], v232 offset:4096
    s_waitcnt lgkmcnt(7)
    v_mfma_f32_16x16x32_bf16 v[80:83], v[152:155], v[120:123], v[80:83]
    v_exp_f32 v243, v65
    s_waitcnt lgkmcnt(6)
    v_mfma_f32_16x16x32_bf16 v[80:83], v[156:159], v[124:127], v[80:83]
    v_exp_f32 v244, v66
    v_mfma_f32_16x16x32_bf16 v[84:87], v[144:147], v[128:131], v[212:215]
    v_exp_f32 v245, v67
    ds_read_b64_tr_b16 v[180:181], v233 offset:0
    v_cvt_pk_bf16_f32 v96, v242, v243
    v_mfma_f32_16x16x32_bf16 v[84:87], v[148:151], v[132:135], v[84:87]
    ds_read_b64_tr_b16 v[182:183], v233 offset:4096
    v_exp_f32 v246, v72
    v_exp_f32 v247, v73
    v_mfma_f32_16x16x32_bf16 v[84:87], v[152:155], v[136:139], v[84:87]
    ds_read_b64_tr_b16 v[184:185], v234 offset:0
    v_cvt_pk_bf16_f32 v97, v244, v245
    ds_read_b64_tr_b16 v[186:187], v234 offset:4096
    v_exp_f32 v242, v74
    v_mfma_f32_16x16x32_bf16 v[84:87], v[156:159], v[140:143], v[84:87]
    v_exp_f32 v243, v75
    ds_read_b64_tr_b16 v[188:189], v235 offset:0
    v_cvt_pk_bf16_f32 v98, v246, v247
    s_waitcnt lgkmcnt(10)
    v_mfma_f32_16x16x32_bf16 v[88:91], v[160:163], v[112:115], v[208:211]
    v_or3_b32 v248, v96, v97, v98
    ds_read_b64_tr_b16 v[190:191], v235 offset:4096
    v_exp_f32 v244, v68
    s_waitcnt lgkmcnt(10)
    v_mfma_f32_16x16x32_bf16 v[88:91], v[164:167], v[116:119], v[88:91]
    ds_read_b64_tr_b16 v[192:193], v236 offset:0
    v_exp_f32 v245, v69
    v_cvt_pk_bf16_f32 v99, v242, v243
    s_waitcnt lgkmcnt(10)
    v_mfma_f32_16x16x32_bf16 v[88:91], v[168:171], v[120:123], v[88:91]
    ds_read_b64_tr_b16 v[194:195], v236 offset:4096
    v_exp_f32 v246, v70
    ds_read_b64_tr_b16 v[196:197], v237 offset:0
    v_exp_f32 v247, v71
    s_waitcnt lgkmcnt(11)
    v_mfma_f32_16x16x32_bf16 v[88:91], v[172:175], v[124:127], v[88:91]
    v_cvt_pk_bf16_f32 v100, v244, v245
    ds_read_b64_tr_b16 v[198:199], v237 offset:4096
    v_or3_b32 v248, v248, v99, v100
    v_mfma_f32_16x16x32_bf16 v[92:95], v[160:163], v[128:131], v[212:215]
    v_exp_f32 v242, v76
    ds_read_b64_tr_b16 v[200:201], v238 offset:0
    v_exp_f32 v243, v77
    v_mfma_f32_16x16x32_bf16 v[92:95], v[164:167], v[132:135], v[92:95]
    ds_read_b64_tr_b16 v[202:203], v238 offset:4096
    v_cvt_pk_bf16_f32 v101, v246, v247
    v_exp_f32 v244, v78
    v_mfma_f32_16x16x32_bf16 v[92:95], v[168:171], v[136:139], v[92:95]
    ds_read_b64_tr_b16 v[204:205], v239 offset:0
    v_exp_f32 v245, v79
    ds_read_b64_tr_b16 v[206:207], v239 offset:4096
    v_cvt_pk_bf16_f32 v102, v242, v243
    v_mfma_f32_16x16x32_bf16 v[92:95], v[172:175], v[140:143], v[92:95]
    v_or3_b32 v248, v248, v101, v102
    v_cvt_pk_bf16_f32 v103, v244, v245
    v_or_b32 v248, v248, v103
    v_and_b32 v248, 0x40004000, v248
    v_cmp_ne_u32 vcc, 0, v248
    s_cbranch_vccnz TR_0
BK_0:
STEP_1:
    s_waitcnt vmcnt(4) lgkmcnt(0)
    s_barrier
    s_setprio 3
    v_mfma_f32_16x16x32_bf16 v[0:3], v[176:179], v[96:99], v[0:3]
    ds_read_b128 v[144:147], v228 offset:24576
    s_cmp_eq_u32 s0, 0
    s_cbranch_scc0 BU1K
    s_add_u32 m0, s72, 49152
    s_add_u32 s26, s72, 40960
    buffer_load_dwordx4 v240, s[32:35], s26 offen offset:0 nt lds
    v_xor_b32 v251, 64, v240
    buffer_load_dwordx4 v251, s[32:35], s26 offen offset:1024 nt lds
    v_xor_b32 v250, 128, v240
    buffer_load_dwordx4 v250, s[32:35], s26 offen offset:2048 nt lds
    v_xor_b32 v251, 192, v240
    buffer_load_dwordx4 v251, s[32:35], s26 offen offset:3072 nt lds
BU1K:
    v_mfma_f32_16x16x32_bf16 v[4:7], v[176:179], v[100:103], v[4:7]
    ds_read_b128 v[148:151], v229 offset:24576
    v_mfma_f32_16x16x32_bf16 v[8:11], v[180:183], v[96:99], v[8:11]
    ds_read_b128 v[152:155], v230 offset:24576
    v_mfma_f32_16x16x32_bf16 v[12:15], v[180:183], v[100:103], v[12:15]
    v_exp_f32 v242, v80
    v_mfma_f32_16x16x32_bf16 v[16:19], v[184:187], v[96:99], v[16:19]
    ds_read_b128 v[156:159], v231 offset:24576
    ds_read_b128 v[160:163], v228 offset:28672
    v_mfma_f32_16x16x32_bf16 v[20:23], v[184:187], v[100:103], v[20:23]
    v_exp_f32 v243, v81
    v_mfma_f32_16x16x32_bf16 v[24:27], v[188:191], v[96:99], v[24:27]
    v_exp_f32 v244, v82
    v_mfma_f32_16x16x32_bf16 v[28:31], v[188:191], v[100:103], v[28:31]
    ds_read_b128 v[164:167], v229 offset:28672
    ds_read_b128 v[168:171], v230 offset:28672
    v_mfma_f32_16x16x32_bf16 v[32:35], v[192:195], v[96:99], v[32:35]
    v_exp_f32 v245, v83
    v_mfma_f32_16x16x32_bf16 v[36:39], v[192:195], v[100:103], v[36:39]
    v_cvt_pk_bf16_f32 v104, v242, v243
    ds_read_b128 v[172:175], v231 offset:28672
    ds_read_b64_tr_b16 v[176:177], v232 offset:8192
    v_mfma_f32_16x16x32_bf16 v[40:43], v[196:199], v[96:99], v[40:43]
    v_exp_f32 v246, v88
    s_setprio 2
    v_mfma_f32_16x16x32_bf16 v[44:47], v[196:199], v[100:103], v[44:47]
    v_exp_f32 v247, v89
    ds_read_b64_tr_b16 v[178:179], v232 offset:12288
    v_mfma_f32_16x16x32_bf16 v[48:51], v[200:203], v[96:99], v[48:51]
    v_cvt_pk_bf16_f32 v105, v244, v245
    ds_read_b64_tr_b16 v[180:181], v233 offset:8192
    v_exp_f32 v242, v90
    v_mfma_f32_16x16x32_bf16 v[52:55], v[200:203], v[100:103], v[52:55]
    ds_read_b64_tr_b16 v[182:183], v233 offset:12288
    v_exp_f32 v243, v91
    v_mfma_f32_16x16x32_bf16 v[56:59], v[204:207], v[96:99], v[56:59]
    ds_read_b64_tr_b16 v[184:185], v234 offset:8192
    v_mfma_f32_16x16x32_bf16 v[60:63], v[204:207], v[100:103], v[60:63]
    v_cvt_pk_bf16_f32 v106, v246, v247
    v_or3_b32 v248, v104, v105, v106
    v_mfma_f32_16x16x32_bf16 v[216:219], v[224:227], v[96:99], v[216:219]
    v_exp_f32 v244, v84
    ds_read_b64_tr_b16 v[186:187], v234 offset:12288
    v_mfma_f32_16x16x32_bf16 v[220:223], v[224:227], v[100:103], v[220:223]
    v_exp_f32 v245, v85
    ds_read_b64_tr_b16 v[188:189], v235 offset:8192
    s_waitcnt lgkmcnt(7)
    v_mfma_f32_16x16x32_bf16 v[64:67], v[144:147], v[112:115], v[208:211]
    v_cvt_pk_bf16_f32 v107, v242, v243
    ds_read_b64_tr_b16 v[190:191], v235 offset:12288
    v_mfma_f32_16x16x32_bf16 v[64:67], v[148:151], v[116:119], v[64:67]
    v_exp_f32 v246, v86
    ds_read_b64_tr_b16 v[192:193], v236 offset:8192
    s_setprio 1
    v_mfma_f32_16x16x32_bf16 v[64:67], v[152:155], v[120:123], v[64:67]
    v_exp_f32 v247, v87
    v_mfma_f32_16x16x32_bf16 v[64:67], v[156:159], v[124:127], v[64:67]
    ds_read_b64_tr_b16 v[194:195], v236 offset:12288
    v_cvt_pk_bf16_f32 v108, v244, v245
    v_or3_b32 v248, v248, v107, v108
    v_mfma_f32_16x16x32_bf16 v[68:71], v[144:147], v[128:131], v[212:215]
    v_exp_f32 v242, v92
    ds_read_b64_tr_b16 v[196:197], v237 offset:8192
    v_mfma_f32_16x16x32_bf16 v[68:71], v[148:151], v[132:135], v[68:71]
    v_exp_f32 v243, v93
    ds_read_b64_tr_b16 v[198:199], v237 offset:12288
    v_mfma_f32_16x16x32_bf16 v[68:71], v[152:155], v[136:139], v[68:71]
    v_cvt_pk_bf16_f32 v109, v246, v247
    ds_read_b64_tr_b16 v[200:201], v238 offset:8192
    v_mfma_f32_16x16x32_bf16 v[68:71], v[156:159], v[140:143], v[68:71]
    v_exp_f32 v244, v94
    v_mfma_f32_16x16x32_bf16 v[72:75], v[160:163], v[112:115], v[208:211]
    ds_read_b64_tr_b16 v[202:203], v238 offset:12288
    v_exp_f32 v245, v95
    v_mfma_f32_16x16x32_bf16 v[72:75], v[164:167], v[116:119], v[72:75]
    v_cvt_pk_bf16_f32 v110, v242, v243
    ds_read_b64_tr_b16 v[204:205], v239 offset:8192
    s_setprio 0
    v_mfma_f32_16x16x32_bf16 v[72:75], v[168:171], v[120:123], v[72:75]
    v_or3_b32 v248, v248, v109, v110
    v_cvt_pk_bf16_f32 v111, v244, v245
    ds_read_b64_tr_b16 v[206:207], v239 offset:12288
    v_mfma_f32_16x16x32_bf16 v[72:75], v[172:175], v[124:127], v[72:75]
    v_or_b32 v248, v248, v111
    v_and_b32 v248, 0x40004000, v248
    v_mfma_f32_16x16x32_bf16 v[76:79], v[160:163], v[128:131], v[212:215]
    v_cmp_ne_u32 vcc, 0, v248
    v_mfma_f32_16x16x32_bf16 v[76:79], v[164:167], v[132:135], v[76:79]
    v_mfma_f32_16x16x32_bf16 v[76:79], v[168:171], v[136:139], v[76:79]
    v_mfma_f32_16x16x32_bf16 v[76:79], v[172:175], v[140:143], v[76:79]
    s_cbranch_vccnz TR_1
BK_1:
STEP_2:
    s_waitcnt vmcnt(4) lgkmcnt(0)
    s_barrier
    s_setprio 3
    v_mfma_f32_16x16x32_bf16 v[0:3], v[176:179], v[104:107], v[0:3]
    ds_read_b128 v[144:147], v228 offset:32768
    s_cmp_eq_u32 s0, 0
    s_cbranch_scc0 BU2V
    s_add_u32 m0, s72, 114688
    s_add_u32 s26, s72, 49152
    buffer_load_dwordx4 v241, s[36:39], s26 offen offset:0 nt lds
    v_xor_b32 v251, 128, v241
    buffer_load_dwordx4 v251, s[36:39], s26 offen offset:1024 nt lds
    buffer_load_dwordx4 v241, s[36:39], s26 offen offset:2048 nt lds
    v_xor_b32 v251, 128, v241
    buffer_load_dwordx4 v251, s[36:39], s26 offen offset:3072 nt lds
BU2V:
    v_mfma_f32_16x16x32_bf16 v[4:7], v[176:179], v[108:111], v[4:7]
    ds_read_b128 v[148:151], v229 offset:32768
    v_mfma_f32_16x16x32_bf16 v[8:11], v[180:183], v[104:107], v[8:11]
    ds_read_b128 v[152:155], v230 offset:32768
    v_mfma_f32_16x16x32_bf16 v[12:15], v[180:183], v[108:111], v[12:15]
    v_exp_f32 v242, v64
    v_mfma_f32_16x16x32_bf16 v[16:19], v[184:187], v[104:107], v[16:19]
    ds_read_b128 v[156:159], v231 offset:32768
    ds_read_b128 v[160:163], v228 offset:36864
    v_mfma_f32_16x16x32_bf16 v[20:23], v[184:187], v[108:111], v[20:23]
    v_exp_f32 v243, v65
    v_mfma_f32_16x16x32_bf16 v[24:27], v[188:191], v[104:107], v[24:27]
    v_exp_f32 v244, v66
    v_mfma_f32_16x16x32_bf16 v[28:31], v[188:191], v[108:111], v[28:31]
    ds_read_b128 v[164:167], v229 offset:36864
    ds_read_b128 v[168:171], v230 offset:36864
    v_mfma_f32_16x16x32_bf16 v[32:35], v[192:195], v[104:107], v[32:35]
    v_exp_f32 v245, v67
    v_mfma_f32_16x16x32_bf16 v[36:39], v[192:195], v[108:111], v[36:39]
    v_cvt_pk_bf16_f32 v96, v242, v243
    ds_read_b128 v[172:175], v231 offset:36864
    ds_read_b64_tr_b16 v[176:177], v232 offset:16384
    v_mfma_f32_16x16x32_bf16 v[40:43], v[196:199], v[104:107], v[40:43]
    v_exp_f32 v246, v72
    s_setprio 2
    v_mfma_f32_16x16x32_bf16 v[44:47], v[196:199], v[108:111], v[44:47]
    v_exp_f32 v247, v73
    ds_read_b64_tr_b16 v[178:179], v232 offset:20480
    v_mfma_f32_16x16x32_bf16 v[48:51], v[200:203], v[104:107], v[48:51]
    v_cvt_pk_bf16_f32 v97, v244, v245
    ds_read_b64_tr_b16 v[180:181], v233 offset:16384
    v_exp_f32 v242, v74
    v_mfma_f32_16x16x32_bf16 v[52:55], v[200:203], v[108:111], v[52:55]
    ds_read_b64_tr_b16 v[182:183], v233 offset:20480
    v_exp_f32 v243, v75
    v_mfma_f32_16x16x32_bf16 v[56:59], v[204:207], v[104:107], v[56:59]
    ds_read_b64_tr_b16 v[184:185], v234 offset:16384
    v_mfma_f32_16x16x32_bf16 v[60:63], v[204:207], v[108:111], v[60:63]
    v_cvt_pk_bf16_f32 v98, v246, v247
    v_or3_b32 v248, v96, v97, v98
    v_mfma_f32_16x16x32_bf16 v[216:219], v[224:227], v[104:107], v[216:219]
    v_exp_f32 v244, v68
    ds_read_b64_tr_b16 v[186:187], v234 offset:20480
    v_mfma_f32_16x16x32_bf16 v[220:223], v[224:227], v[108:111], v[220:223]
    v_exp_f32 v245, v69
    ds_read_b64_tr_b16 v[188:189], v235 offset:16384
    s_waitcnt lgkmcnt(7)
    v_mfma_f32_16x16x32_bf16 v[80:83], v[144:147], v[112:115], v[208:211]
    v_cvt_pk_bf16_f32 v99, v242, v243
    ds_read_b64_tr_b16 v[190:191], v235 offset:20480
    v_mfma_f32_16x16x32_bf16 v[80:83], v[148:151], v[116:119], v[80:83]
    v_exp_f32 v246, v70
    ds_read_b64_tr_b16 v[192:193], v236 offset:16384
    s_setprio 1
    v_mfma_f32_16x16x32_bf16 v[80:83], v[152:155], v[120:123], v[80:83]
    v_exp_f32 v247, v71
    v_mfma_f32_16x16x32_bf16 v[80:83], v[156:159], v[124:127], v[80:83]
    ds_read_b64_tr_b16 v[194:195], v236 offset:20480
    v_cvt_pk_bf16_f32 v100, v244, v245
    v_or3_b32 v248, v248, v99, v100
    v_mfma_f32_16x16x32_bf16 v[84:87], v[144:147], v[128:131], v[212:215]
    v_exp_f32 v242, v76
    ds_read_b64_tr_b16 v[196:197], v237 offset:16384
    v_mfma_f32_16x16x32_bf16 v[84:87], v[148:151], v[132:135], v[84:87]
    v_exp_f32 v243, v77
    ds_read_b64_tr_b16 v[198:199], v237 offset:20480
    v_mfma_f32_16x16x32_bf16 v[84:87], v[152:155], v[136:139], v[84:87]
    v_cvt_pk_bf16_f32 v101, v246, v247
    ds_read_b64_tr_b16 v[200:201], v238 offset:16384
    v_mfma_f32_16x16x32_bf16 v[84:87], v[156:159], v[140:143], v[84:87]
    v_exp_f32 v244, v78
    v_mfma_f32_16x16x32_bf16 v[88:91], v[160:163], v[112:115], v[208:211]
    ds_read_b64_tr_b16 v[202:203], v238 offset:20480
    v_exp_f32 v245, v79
    v_mfma_f32_16x16x32_bf16 v[88:91], v[164:167], v[116:119], v[88:91]
    v_cvt_pk_bf16_f32 v102, v242, v243
    ds_read_b64_tr_b16 v[204:205], v239 offset:16384
    s_setprio 0
    v_mfma_f32_16x16x32_bf16 v[88:91], v[168:171], v[120:123], v[88:91]
    v_or3_b32 v248, v248, v101, v102
    v_cvt_pk_bf16_f32 v103, v244, v245
    ds_read_b64_tr_b16 v[206:207], v239 offset:20480
    v_mfma_f32_16x16x32_bf16 v[88:91], v[172:175], v[124:127], v[88:91]
    v_or_b32 v248, v248, v103
    v_and_b32 v248, 0x40004000, v248
    v_mfma_f32_16x16x32_bf16 v[92:95], v[160:163], v[128:131], v[212:215]
    v_cmp_ne_u32 vcc, 0, v248
    v_mfma_f32_16x16x32_bf16 v[92:95], v[164:167], v[132:135], v[92:95]
    v_mfma_f32_16x16x32_bf16 v[92:95], v[168:171], v[136:139], v[92:95]
    v_mfma_f32_16x16x32_bf16 v[92:95], v[172:175], v[140:143], v[92:95]
    s_cbranch_vccnz TR_2
BK_2:
STEP_3:
    s_waitcnt lgkmcnt(0)
    s_cmp_eq_u32 s0, 0
    s_cbranch_scc0 NB3
    s_waitcnt vmcnt(0)
    s_barrier
NB3:
    s_setprio 3
    v_mfma_f32_16x16x32_bf16 v[0:3], v[176:179], v[96:99], v[0:3]
    ds_read_b128 v[144:147], v228 offset:40960
    v_mfma_f32_16x16x32_bf16 v[4:7], v[176:179], v[100:103], v[4:7]
    ds_read_b128 v[148:151], v229 offset:40960
    v_mfma_f32_16x16x32_bf16 v[8:11], v[180:183], v[96:99], v[8:11]
    ds_read_b128 v[152:155], v230 offset:40960
    v_mfma_f32_16x16x32_bf16 v[12:15], v[180:183], v[100:103], v[12:15]
    v_exp_f32 v242, v80
    v_mfma_f32_16x16x32_bf16 v[16:19], v[184:187], v[96:99], v[16:19]
    ds_read_b128 v[156:159], v231 offset:40960
    ds_read_b128 v[160:163], v228 offset:45056
    v_mfma_f32_16x16x32_bf16 v[20:23], v[184:187], v[100:103], v[20:23]
    v_exp_f32 v243, v81
    v_mfma_f32_16x16x32_bf16 v[24:27], v[188:191], v[96:99], v[24:27]
    v_exp_f32 v244, v82
    v_mfma_f32_16x16x32_bf16 v[28:31], v[188:191], v[100:103], v[28:31]
    ds_read_b128 v[164:167], v229 offset:45056
    ds_read_b128 v[168:171], v230 offset:45056
    v_mfma_f32_16x16x32_bf16 v[32:35], v[192:195], v[96:99], v[32:35]
    v_exp_f32 v245, v83
    v_mfma_f32_16x16x32_bf16 v[36:39], v[192:195], v[100:103], v[36:39]
    v_cvt_pk_bf16_f32 v104, v242, v243
    ds_read_b128 v[172:175], v231 offset:45056
    ds_read_b64_tr_b16 v[176:177], v232 offset:24576
    v_mfma_f32_16x16x32_bf16 v[40:43], v[196:199], v[96:99], v[40:43]
    v_exp_f32 v246, v88
    s_setprio 2
    v_mfma_f32_16x16x32_bf16 v[44:47], v[196:199], v[100:103], v[44:47]
    v_exp_f32 v247, v89
    ds_read_b64_tr_b16 v[178:179], v232 offset:28672
    v_mfma_f32_16x16x32_bf16 v[48:51], v[200:203], v[96:99], v[48:51]
    v_cvt_pk_bf16_f32 v105, v244, v245
    ds_read_b64_tr_b16 v[180:181], v233 offset:24576
    v_exp_f32 v242, v90
    v_mfma_f32_16x16x32_bf16 v[52:55], v[200:203], v[100:103], v[52:55]
    ds_read_b64_tr_b16 v[182:183], v233 offset:28672
    v_exp_f32 v243, v91
    v_mfma_f32_16x16x32_bf16 v[56:59], v[204:207], v[96:99], v[56:59]
    ds_read_b64_tr_b16 v[184:185], v234 offset:24576
    v_mfma_f32_16x16x32_bf16 v[60:63], v[204:207], v[100:103], v[60:63]
    v_cvt_pk_bf16_f32 v106, v246, v247
    v_or3_b32 v248, v104, v105, v106
    v_mfma_f32_16x16x32_bf16 v[216:219], v[224:227], v[96:99], v[216:219]
    v_exp_f32 v244, v84
    ds_read_b64_tr_b16 v[186:187], v234 offset:28672
    v_mfma_f32_16x16x32_bf16 v[220:223], v[224:227], v[100:103], v[220:223]
    v_exp_f32 v245, v85
    ds_read_b64_tr_b16 v[188:189], v235 offset:24576
    s_waitcnt lgkmcnt(7)
    v_mfma_f32_16x16x32_bf16 v[64:67], v[144:147], v[112:115], v[208:211]
    v_cvt_pk_bf16_f32 v107, v242, v243
    ds_read_b64_tr_b16 v[190:191], v235 offset:28672
    v_mfma_f32_16x16x32_bf16 v[64:67], v[148:151], v[116:119], v[64:67]
    v_exp_f32 v246, v86
    ds_read_b64_tr_b16 v[192:193], v236 offset:24576
    s_setprio 1
    v_mfma_f32_16x16x32_bf16 v[64:67], v[152:155], v[120:123], v[64:67]
    v_exp_f32 v247, v87
    v_mfma_f32_16x16x32_bf16 v[64:67], v[156:159], v[124:127], v[64:67]
    ds_read_b64_tr_b16 v[194:195], v236 offset:28672
    v_cvt_pk_bf16_f32 v108, v244, v245
    v_or3_b32 v248, v248, v107, v108
    v_mfma_f32_16x16x32_bf16 v[68:71], v[144:147], v[128:131], v[212:215]
    v_exp_f32 v242, v92
    ds_read_b64_tr_b16 v[196:197], v237 offset:24576
    v_mfma_f32_16x16x32_bf16 v[68:71], v[148:151], v[132:135], v[68:71]
    v_exp_f32 v243, v93
    ds_read_b64_tr_b16 v[198:199], v237 offset:28672
    v_mfma_f32_16x16x32_bf16 v[68:71], v[152:155], v[136:139], v[68:71]
    v_cvt_pk_bf16_f32 v109, v246, v247
    ds_read_b64_tr_b16 v[200:201], v238 offset:24576
    v_mfma_f32_16x16x32_bf16 v[68:71], v[156:159], v[140:143], v[68:71]
    v_exp_f32 v244, v94
    v_mfma_f32_16x16x32_bf16 v[72:75], v[160:163], v[112:115], v[208:211]
    ds_read_b64_tr_b16 v[202:203], v238 offset:28672
    v_exp_f32 v245, v95
    v_mfma_f32_16x16x32_bf16 v[72:75], v[164:167], v[116:119], v[72:75]
    v_cvt_pk_bf16_f32 v110, v242, v243
    ds_read_b64_tr_b16 v[204:205], v239 offset:24576
    s_setprio 0
    v_mfma_f32_16x16x32_bf16 v[72:75], v[168:171], v[120:123], v[72:75]
    v_or3_b32 v248, v248, v109, v110
    v_cvt_pk_bf16_f32 v111, v244, v245
    ds_read_b64_tr_b16 v[206:207], v239 offset:28672
    v_mfma_f32_16x16x32_bf16 v[72:75], v[172:175], v[124:127], v[72:75]
    v_or_b32 v248, v248, v111
    v_and_b32 v248, 0x40004000, v248
    v_mfma_f32_16x16x32_bf16 v[76:79], v[160:163], v[128:131], v[212:215]
    v_cmp_ne_u32 vcc, 0, v248
    v_mfma_f32_16x16x32_bf16 v[76:79], v[164:167], v[132:135], v[76:79]
    v_mfma_f32_16x16x32_bf16 v[76:79], v[168:171], v[136:139], v[76:79]
    v_mfma_f32_16x16x32_bf16 v[76:79], v[172:175], v[140:143], v[76:79]
    s_cbranch_vccnz TR_3
BK_3:
STEP_4:
    s_waitcnt vmcnt(4) lgkmcnt(0)
    s_barrier
    s_setprio 3
    v_mfma_f32_16x16x32_bf16 v[0:3], v[176:179], v[104:107], v[0:3]
    ds_read_b128 v[144:147], v228 offset:49152
    v_mfma_f32_16x16x32_bf16 v[4:7], v[176:179], v[108:111], v[4:7]
    ds_read_b128 v[148:151], v229 offset:49152
    v_mfma_f32_16x16x32_bf16 v[8:11], v[180:183], v[104:107], v[8:11]
    ds_read_b128 v[152:155], v230 offset:49152
    v_mfma_f32_16x16x32_bf16 v[12:15], v[180:183], v[108:111], v[12:15]
    v_exp_f32 v242, v64
    v_mfma_f32_16x16x32_bf16 v[16:19], v[184:187], v[104:107], v[16:19]
    ds_read_b128 v[156:159], v231 offset:49152
    ds_read_b128 v[160:163], v228 offset:53248
    v_mfma_f32_16x16x32_bf16 v[20:23], v[184:187], v[108:111], v[20:23]
    v_exp_f32 v243, v65
    v_mfma_f32_16x16x32_bf16 v[24:27], v[188:191], v[104:107], v[24:27]
    v_exp_f32 v244, v66
    v_mfma_f32_16x16x32_bf16 v[28:31], v[188:191], v[108:111], v[28:31]
    ds_read_b128 v[164:167], v229 offset:53248
    ds_read_b128 v[168:171], v230 offset:53248
    v_mfma_f32_16x16x32_bf16 v[32:35], v[192:195], v[104:107], v[32:35]
    v_exp_f32 v245, v67
    s_cmp_lg_u32 s24, s96
    s_cbranch_scc1 SY4
    v_lshlrev_b32 v250, 3, v249
    v_mov_b32 v254, 0xbf800000
    v_mov_b32 v255, 0xbf800000
    buffer_store_dwordx2 v[254:255], v250, s[76:79], 0 offen offset:0 sc1
    buffer_store_dwordx2 v[254:255], v250, s[76:79], 0 offen offset:512 sc1
    buffer_store_dwordx2 v[254:255], v250, s[76:79], 0 offen offset:1024 sc1
    buffer_store_dwordx2 v[254:255], v250, s[76:79], 0 offen offset:1536 sc1
SY4:
    v_mfma_f32_16x16x32_bf16 v[36:39], v[192:195], v[108:111], v[36:39]
    v_cvt_pk_bf16_f32 v96, v242, v243
    ds_read_b128 v[172:175], v231 offset:53248
    ds_read_b64_tr_b16 v[176:177], v232 offset:32768
    v_mfma_f32_16x16x32_bf16 v[40:43], v[196:199], v[104:107], v[40:43]
    v_exp_f32 v246, v72
    v_mfma_f32_16x16x32_bf16 v[44:47], v[196:199], v[108:111], v[44:47]
    v_exp_f32 v247, v73
    ds_read_b64_tr_b16 v[178:179], v232 offset:36864
    v_mfma_f32_16x16x32_bf16 v[48:51], v[200:203], v[104:107], v[48:51]
    v_cvt_pk_bf16_f32 v97, v244, v245
    ds_read_b64_tr_b16 v[180:181], v233 offset:32768
    v_exp_f32 v242, v74
    v_mfma_f32_16x16x32_bf16 v[52:55], v[200:203], v[108:111], v[52:55]
    ds_read_b64_tr_b16 v[182:183], v233 offset:36864
    v_exp_f32 v243, v75
    v_mfma_f32_16x16x32_bf16 v[56:59], v[204:207], v[104:107], v[56:59]
    ds_read_b64_tr_b16 v[184:185], v234 offset:32768
    v_mfma_f32_16x16x32_bf16 v[60:63], v[204:207], v[108:111], v[60:63]
    v_cvt_pk_bf16_f32 v98, v246, v247
    v_or3_b32 v248, v96, v97, v98
    v_mfma_f32_16x16x32_bf16 v[216:219], v[224:227], v[104:107], v[216:219]
    v_exp_f32 v244, v68
    ds_read_b64_tr_b16 v[186:187], v234 offset:36864
    v_mfma_f32_16x16x32_bf16 v[220:223], v[224:227], v[108:111], v[220:223]
    v_exp_f32 v245, v69
    ds_read_b64_tr_b16 v[188:189], v235 offset:32768
    s_waitcnt lgkmcnt(7)
    v_mfma_f32_16x16x32_bf16 v[80:83], v[144:147], v[112:115], v[208:211]
    v_cvt_pk_bf16_f32 v99, v242, v243
    ds_read_b64_tr_b16 v[190:191], v235 offset:36864
    v_mfma_f32_16x16x32_bf16 v[80:83], v[148:151], v[116:119], v[80:83]
    v_exp_f32 v246, v70
    ds_read_b64_tr_b16 v[192:193], v236 offset:32768
    s_setprio 2
    v_mfma_f32_16x16x32_bf16 v[80:83], v[152:155], v[120:123], v[80:83]
    v_exp_f32 v247, v71
    v_mfma_f32_16x16x32_bf16 v[80:83], v[156:159], v[124:127], v[80:83]
    ds_read_b64_tr_b16 v[194:195], v236 offset:36864
    v_cvt_pk_bf16_f32 v100, v244, v245
    v_or3_b32 v248, v248, v99, v100
    v_mfma_f32_16x16x32_bf16 v[84:87], v[144:147], v[128:131], v[212:215]
    v_exp_f32 v242, v76
    ds_read_b64_tr_b16 v[196:197], v237 offset:32768
    v_mfma_f32_16x16x32_bf16 v[84:87], v[148:151], v[132:135], v[84:87]
    v_exp_f32 v243, v77
    ds_read_b64_tr_b16 v[198:199], v237 offset:36864
    v_mfma_f32_16x16x32_bf16 v[84:87], v[152:155], v[136:139], v[84:87]
    v_cvt_pk_bf16_f32 v101, v246, v247
    ds_read_b64_tr_b16 v[200:201], v238 offset:32768
    v_mfma_f32_16x16x32_bf16 v[84:87], v[156:159], v[140:143], v[84:87]
    v_exp_f32 v244, v78
    v_mfma_f32_16x16x32_bf16 v[88:91], v[160:163], v[112:115], v[208:211]
    ds_read_b64_tr_b16 v[202:203], v238 offset:36864
    v_exp_f32 v245, v79
    v_mfma_f32_16x16x32_bf16 v[88:91], v[164:167], v[116:119], v[88:91]
    v_cvt_pk_bf16_f32 v102, v242, v243
    ds_read_b64_tr_b16 v[204:205], v239 offset:32768
    v_mfma_f32_16x16x32_bf16 v[88:91], v[168:171], v[120:123], v[88:91]
    v_or3_b32 v248, v248, v101, v102
    v_cvt_pk_bf16_f32 v103, v244, v245
    ds_read_b64_tr_b16 v[206:207], v239 offset:36864
    v_mfma_f32_16x16x32_bf16 v[88:91], v[172:175], v[124:127], v[88:91]
    v_or_b32 v248, v248, v103
    v_and_b32 v248, 0x40004000, v248
    v_mfma_f32_16x16x32_bf16 v[92:95], v[160:163], v[128:131], v[212:215]
    v_cmp_ne_u32 vcc, 0, v248
    s_cmp_eq_u32 s0, 0
    s_cbranch_scc0 BU4K
    s_add_u32 m0, s72, 0
    s_add_u32 s26, s72, 57344
    buffer_load_dwordx4 v240, s[32:35], s26 offen offset:0 nt lds
    v_xor_b32 v251, 64, v240
    buffer_load_dwordx4 v251, s[32:35], s26 offen offset:1024 nt lds
    v_xor_b32 v250, 128, v240
    buffer_load_dwordx4 v250, s[32:35], s26 offen offset:2048 nt lds
    v_xor_b32 v251, 192, v240
    buffer_load_dwordx4 v251, s[32:35], s26 offen offset:3072 nt lds
BU4K:
    v_mfma_f32_16x16x32_bf16 v[92:95], v[164:167], v[132:135], v[92:95]
    v_mfma_f32_16x16x32_bf16 v[92:95], v[168:171], v[136:139], v[92:95]
    v_mfma_f32_16x16x32_bf16 v[92:95], v[172:175], v[140:143], v[92:95]
    s_cbranch_vccnz TR_4
BK_4:
STEP_5:
    s_waitcnt lgkmcnt(0)
    s_setprio 1
    v_mfma_f32_16x16x32_bf16 v[0:3], v[176:179], v[96:99], v[0:3]
    ds_read_b128 v[144:147], v228 offset:57344
    s_cmp_eq_u32 s0, 0
    s_cbranch_scc0 BU5V
    s_add_u32 m0, s72, 65536
    s_add_u32 s26, s72, 65536
    buffer_load_dwordx4 v241, s[36:39], s26 offen offset:0 nt lds
    v_xor_b32 v251, 128, v241
    buffer_load_dwordx4 v251, s[36:39], s26 offen offset:1024 nt lds
    buffer_load_dwordx4 v241, s[36:39], s26 offen offset:2048 nt lds
    v_xor_b32 v251, 128, v241
    buffer_load_dwordx4 v251, s[36:39], s26 offen offset:3072 nt lds
BU5V:
    v_mfma_f32_16x16x32_bf16 v[4:7], v[176:179], v[100:103], v[4:7]
    ds_read_b128 v[148:151], v229 offset:57344
    v_mfma_f32_16x16x32_bf16 v[8:11], v[180:183], v[96:99], v[8:11]
    ds_read_b128 v[152:155], v230 offset:57344
    v_mfma_f32_16x16x32_bf16 v[12:15], v[180:183], v[100:103], v[12:15]
    v_exp_f32 v242, v80
    v_mfma_f32_16x16x32_bf16 v[16:19], v[184:187], v[96:99], v[16:19]
    ds_read_b128 v[156:159], v231 offset:57344
    ds_read_b128 v[160:163], v228 offset:61440
    v_mfma_f32_16x16x32_bf16 v[20:23], v[184:187], v[100:103], v[20:23]
    v_exp_f32 v243, v81
    v_mfma_f32_16x16x32_bf16 v[24:27], v[188:191], v[96:99], v[24:27]
    v_exp_f32 v244, v82
    v_mfma_f32_16x16x32_bf16 v[28:31], v[188:191], v[100:103], v[28:31]
    ds_read_b128 v[164:167], v229 offset:61440
    ds_read_b128 v[168:171], v230 offset:61440
    v_mfma_f32_16x16x32_bf16 v[32:35], v[192:195], v[96:99], v[32:35]
    v_exp_f32 v245, v83
    v_mfma_f32_16x16x32_bf16 v[36:39], v[192:195], v[100:103], v[36:39]
    v_cvt_pk_bf16_f32 v104, v242, v243
    ds_read_b128 v[172:175], v231 offset:61440
    ds_read_b64_tr_b16 v[176:177], v232 offset:40960
    v_mfma_f32_16x16x32_bf16 v[40:43], v[196:199], v[96:99], v[40:43]
    v_exp_f32 v246, v88
    v_mfma_f32_16x16x32_bf16 v[44:47], v[196:199], v[100:103], v[44:47]
    v_exp_f32 v247, v89
    ds_read_b64_tr_b16 v[178:179], v232 offset:45056
    v_mfma_f32_16x16x32_bf16 v[48:51], v[200:203], v[96:99], v[48:51]
    v_cvt_pk_bf16_f32 v105, v244, v245
    ds_read_b64_tr_b16 v[180:181], v233 offset:40960
    v_exp_f32 v242, v90
    v_mfma_f32_16x16x32_bf16 v[52:55], v[200:203], v[100:103], v[52:55]
    ds_read_b64_tr_b16 v[182:183], v233 offset:45056
    v_exp_f32 v243, v91
    v_mfma_f32_16x16x32_bf16 v[56:59], v[204:207], v[96:99], v[56:59]
    ds_read_b64_tr_b16 v[184:185], v234 offset:40960
    v_mfma_f32_16x16x32_bf16 v[60:63], v[204:207], v[100:103], v[60:63]
    v_cvt_pk_bf16_f32 v106, v246, v247
    v_or3_b32 v248, v104, v105, v106
    v_mfma_f32_16x16x32_bf16 v[216:219], v[224:227], v[96:99], v[216:219]
    v_exp_f32 v244, v84
    ds_read_b64_tr_b16 v[186:187], v234 offset:45056
    v_mfma_f32_16x16x32_bf16 v[220:223], v[224:227], v[100:103], v[220:223]
    v_exp_f32 v245, v85
    ds_read_b64_tr_b16 v[188:189], v235 offset:40960
    s_waitcnt lgkmcnt(7)
    v_mfma_f32_16x16x32_bf16 v[64:67], v[144:147], v[112:115], v[208:211]
    v_cvt_pk_bf16_f32 v107, v242, v243
    ds_read_b64_tr_b16 v[190:191], v235 offset:45056
    v_mfma_f32_16x16x32_bf16 v[64:67], v[148:151], v[116:119], v[64:67]
    v_exp_f32 v246, v86
    ds_read_b64_tr_b16 v[192:193], v236 offset:40960
    s_setprio 0
    v_mfma_f32_16x16x32_bf16 v[64:67], v[152:155], v[120:123], v[64:67]
    v_exp_f32 v247, v87
    v_mfma_f32_16x16x32_bf16 v[64:67], v[156:159], v[124:127], v[64:67]
    ds_read_b64_tr_b16 v[194:195], v236 offset:45056
    v_cvt_pk_bf16_f32 v108, v244, v245
    v_or3_b32 v248, v248, v107, v108
    v_mfma_f32_16x16x32_bf16 v[68:71], v[144:147], v[128:131], v[212:215]
    v_exp_f32 v242, v92
    ds_read_b64_tr_b16 v[196:197], v237 offset:40960
    v_mfma_f32_16x16x32_bf16 v[68:71], v[148:151], v[132:135], v[68:71]
    v_exp_f32 v243, v93
    ds_read_b64_tr_b16 v[198:199], v237 offset:45056
    v_mfma_f32_16x16x32_bf16 v[68:71], v[152:155], v[136:139], v[68:71]
    v_cvt_pk_bf16_f32 v109, v246, v247
    ds_read_b64_tr_b16 v[200:201], v238 offset:40960
    v_mfma_f32_16x16x32_bf16 v[68:71], v[156:159], v[140:143], v[68:71]
    v_exp_f32 v244, v94
    v_mfma_f32_16x16x32_bf16 v[72:75], v[160:163], v[112:115], v[208:211]
    ds_read_b64_tr_b16 v[202:203], v238 offset:45056
    v_exp_f32 v245, v95
    v_mfma_f32_16x16x32_bf16 v[72:75], v[164:167], v[116:119], v[72:75]
    v_cvt_pk_bf16_f32 v110, v242, v243
    ds_read_b64_tr_b16 v[204:205], v239 offset:40960
    v_mfma_f32_16x16x32_bf16 v[72:75], v[168:171], v[120:123], v[72:75]
    v_or3_b32 v248, v248, v109, v110
    v_cvt_pk_bf16_f32 v111, v244, v245
    ds_read_b64_tr_b16 v[206:207], v239 offset:45056
    v_mfma_f32_16x16x32_bf16 v[72:75], v[172:175], v[124:127], v[72:75]
    v_or_b32 v248, v248, v111
    v_and_b32 v248, 0x40004000, v248
    v_mfma_f32_16x16x32_bf16 v[76:79], v[160:163], v[128:131], v[212:215]
    v_cmp_ne_u32 vcc, 0, v248
    v_mfma_f32_16x16x32_bf16 v[76:79], v[164:167], v[132:135], v[76:79]
    v_mfma_f32_16x16x32_bf16 v[76:79], v[168:171], v[136:139], v[76:79]
    v_mfma_f32_16x16x32_bf16 v[76:79], v[172:175], v[140:143], v[76:79]
    s_cbranch_vccnz TR_5
BK_5:
STEP_6:
    s_waitcnt vmcnt(4) lgkmcnt(0)
    s_barrier
    s_setprio 3
    v_mfma_f32_16x16x32_bf16 v[0:3], v[176:179], v[104:107], v[0:3]
    ds_read_b128 v[144:147], v228 offset:0
    s_cmp_eq_u32 s0, 0
    s_cbranch_scc0 BU6K
    s_add_u32 m0, s72, 16384
    s_add_u32 s26, s72, 73728
    buffer_load_dwordx4 v240, s[32:35], s26 offen offset:0 nt lds
    v_xor_b32 v251, 64, v240
    buffer_load_dwordx4 v251, s[32:35], s26 offen offset:1024 nt lds
    v_xor_b32 v250, 128, v240
    buffer_load_dwordx4 v250, s[32:35], s26 offen offset:2048 nt lds
    v_xor_b32 v251, 192, v240
    buffer_load_dwordx4 v251, s[32:35], s26 offen offset:3072 nt lds
BU6K:
    v_mfma_f32_16x16x32_bf16 v[4:7], v[176:179], v[108:111], v[4:7]
    ds_read_b128 v[148:151], v229 offset:0
    v_mfma_f32_16x16x32_bf16 v[8:11], v[180:183], v[104:107], v[8:11]
    ds_read_b128 v[152:155], v230 offset:0
    v_mfma_f32_16x16x32_bf16 v[12:15], v[180:183], v[108:111], v[12:15]
    v_exp_f32 v242, v64
    v_mfma_f32_16x16x32_bf16 v[16:19], v[184:187], v[104:107], v[16:19]
    ds_read_b128 v[156:159], v231 offset:0
    ds_read_b128 v[160:163], v228 offset:4096
    v_mfma_f32_16x16x32_bf16 v[20:23], v[184:187], v[108:111], v[20:23]
    v_exp_f32 v243, v65
    v_mfma_f32_16x16x32_bf16 v[24:27], v[188:191], v[104:107], v[24:27]
    v_exp_f32 v244, v66
    v_mfma_f32_16x16x32_bf16 v[28:31], v[188:191], v[108:111], v[28:31]
    ds_read_b128 v[164:167], v229 offset:4096
    ds_read_b128 v[168:171], v230 offset:4096
    v_mfma_f32_16x16x32_bf16 v[32:35], v[192:195], v[104:107], v[32:35]
    v_exp_f32 v245, v67
    v_mfma_f32_16x16x32_bf16 v[36:39], v[192:195], v[108:111], v[36:39]
    v_cvt_pk_bf16_f32 v96, v242, v243
    ds_read_b128 v[172:175], v231 offset:4096
    ds_read_b64_tr_b16 v[176:177], v232 offset:49152
    v_mfma_f32_16x16x32_bf16 v[40:43], v[196:199], v[104:107], v[40:43]
    v_exp_f32 v246, v72
    v_mfma_f32_16x16x32_bf16 v[44:47], v[196:199], v[108:111], v[44:47]
    v_exp_f32 v247, v73
    ds_read_b64_tr_b16 v[178:179], v232 offset:53248
    v_mfma_f32_16x16x32_bf16 v[48:51], v[200:203], v[104:107], v[48:51]
    v_cvt_pk_bf16_f32 v97, v244, v245
    ds_read_b64_tr_b16 v[180:181], v233 offset:49152
    v_exp_f32 v242, v74
    v_mfma_f32_16x16x32_bf16 v[52:55], v[200:203], v[108:111], v[52:55]
    ds_read_b64_tr_b16 v[182:183], v233 offset:53248
    v_exp_f32 v243, v75
    v_mfma_f32_16x16x32_bf16 v[56:59], v[204:207], v[104:107], v[56:59]
    ds_read_b64_tr_b16 v[184:185], v234 offset:49152
    v_mfma_f32_16x16x32_bf16 v[60:63], v[204:207], v[108:111], v[60:63]
    v_cvt_pk_bf16_f32 v98, v246, v247
    v_or3_b32 v248, v96, v97, v98
    v_mfma_f32_16x16x32_bf16 v[216:219], v[224:227], v[104:107], v[216:219]
    v_exp_f32 v244, v68
    ds_read_b64_tr_b16 v[186:187], v234 offset:53248
    v_mfma_f32_16x16x32_bf16 v[220:223], v[224:227], v[108:111], v[220:223]
    v_exp_f32 v245, v69
    ds_read_b64_tr_b16 v[188:189], v235 offset:49152
    s_waitcnt lgkmcnt(7)
    v_mfma_f32_16x16x32_bf16 v[80:83], v[144:147], v[112:115], v[208:211]
    v_cvt_pk_bf16_f32 v99, v242, v243
    ds_read_b64_tr_b16 v[190:191], v235 offset:53248
    v_mfma_f32_16x16x32_bf16 v[80:83], v[148:151], v[116:119], v[80:83]
    v_exp_f32 v246, v70
    ds_read_b64_tr_b16 v[192:193], v236 offset:49152
    s_setprio 2
    v_mfma_f32_16x16x32_bf16 v[80:83], v[152:155], v[120:123], v[80:83]
    v_exp_f32 v247, v71
    v_mfma_f32_16x16x32_bf16 v[80:83], v[156:159], v[124:127], v[80:83]
    ds_read_b64_tr_b16 v[194:195], v236 offset:53248
    v_cvt_pk_bf16_f32 v100, v244, v245
    v_or3_b32 v248, v248, v99, v100
    v_mfma_f32_16x16x32_bf16 v[84:87], v[144:147], v[128:131], v[212:215]
    v_exp_f32 v242, v76
    ds_read_b64_tr_b16 v[196:197], v237 offset:49152
    v_mfma_f32_16x16x32_bf16 v[84:87], v[148:151], v[132:135], v[84:87]
    v_exp_f32 v243, v77
    ds_read_b64_tr_b16 v[198:199], v237 offset:53248
    v_mfma_f32_16x16x32_bf16 v[84:87], v[152:155], v[136:139], v[84:87]
    v_cvt_pk_bf16_f32 v101, v246, v247
    ds_read_b64_tr_b16 v[200:201], v238 offset:49152
    v_mfma_f32_16x16x32_bf16 v[84:87], v[156:159], v[140:143], v[84:87]
    v_exp_f32 v244, v78
    v_mfma_f32_16x16x32_bf16 v[88:91], v[160:163], v[112:115], v[208:211]
    ds_read_b64_tr_b16 v[202:203], v238 offset:53248
    v_exp_f32 v245, v79
    v_mfma_f32_16x16x32_bf16 v[88:91], v[164:167], v[116:119], v[88:91]
    v_cvt_pk_bf16_f32 v102, v242, v243
    ds_read_b64_tr_b16 v[204:205], v239 offset:49152
    v_mfma_f32_16x16x32_bf16 v[88:91], v[168:171], v[120:123], v[88:91]
    v_or3_b32 v248, v248, v101, v102
    v_cvt_pk_bf16_f32 v103, v244, v245
    ds_read_b64_tr_b16 v[206:207], v239 offset:53248
    v_mfma_f32_16x16x32_bf16 v[88:91], v[172:175], v[124:127], v[88:91]
    v_or_b32 v248, v248, v103
    v_and_b32 v248, 0x40004000, v248
    v_mfma_f32_16x16x32_bf16 v[92:95], v[160:163], v[128:131], v[212:215]
    v_cmp_ne_u32 vcc, 0, v248
    v_mfma_f32_16x16x32_bf16 v[92:95], v[164:167], v[132:135], v[92:95]
    v_mfma_f32_16x16x32_bf16 v[92:95], v[168:171], v[136:139], v[92:95]
    v_mfma_f32_16x16x32_bf16 v[92:95], v[172:175], v[140:143], v[92:95]
    s_cbranch_vccnz TR_6
BK_6:
STEP_7:
    s_waitcnt lgkmcnt(0)
    s_setprio 1
    v_mfma_f32_16x16x32_bf16 v[0:3], v[176:179], v[96:99], v[0:3]
    ds_read_b128 v[144:147], v228 offset:8192
    s_cmp_eq_u32 s0, 0
    s_cbranch_scc0 BU7V
    s_add_u32 m0, s72, 81920
    s_add_u32 s26, s72, 81920
    buffer_load_dwordx4 v241, s[36:39], s26 offen offset:0 nt lds
    v_xor_b32 v251, 128, v241
    buffer_load_dwordx4 v251, s[36:39], s26 offen offset:1024 nt lds
    buffer_load_dwordx4 v241, s[36:39], s26 offen offset:2048 nt lds
    v_xor_b32 v251, 128, v241
    buffer_load_dwordx4 v251, s[36:39], s26 offen offset:3072 nt lds
BU7V:
    v_mfma_f32_16x16x32_bf16 v[4:7], v[176:179], v[100:103], v[4:7]
    ds_read_b128 v[148:151], v229 offset:8192
    v_mfma_f32_16x16x32_bf16 v[8:11], v[180:183], v[96:99], v[8:11]
    ds_read_b128 v[152:155], v230 offset:8192
    v_mfma_f32_16x16x32_bf16 v[12:15], v[180:183], v[100:103], v[12:15]
    v_exp_f32 v242, v80
    v_mfma_f32_16x16x32_bf16 v[16:19], v[184:187], v[96:99], v[16:19]
    ds_read_b128 v[156:159], v231 offset:8192
    ds_read_b128 v[160:163], v228 offset:12288
    v_mfma_f32_16x16x32_bf16 v[20:23], v[184:187], v[100:103], v[20:23]
    v_exp_f32 v243, v81
    v_mfma_f32_16x16x32_bf16 v[24:27], v[188:191], v[96:99], v[24:27]
    v_exp_f32 v244, v82
    v_mfma_f32_16x16x32_bf16 v[28:31], v[188:191], v[100:103], v[28:31]
    ds_read_b128 v[164:167], v229 offset:12288
    ds_read_b128 v[168:171], v230 offset:12288
    v_mfma_f32_16x16x32_bf16 v[32:35], v[192:195], v[96:99], v[32:35]
    v_exp_f32 v245, v83
    v_mfma_f32_16x16x32_bf16 v[36:39], v[192:195], v[100:103], v[36:39]
    v_cvt_pk_bf16_f32 v104, v242, v243
    ds_read_b128 v[172:175], v231 offset:12288
    ds_read_b64_tr_b16 v[176:177], v232 offset:57344
    v_mfma_f32_16x16x32_bf16 v[40:43], v[196:199], v[96:99], v[40:43]
    v_exp_f32 v246, v88
    v_mfma_f32_16x16x32_bf16 v[44:47], v[196:199], v[100:103], v[44:47]
    v_exp_f32 v247, v89
    ds_read_b64_tr_b16 v[178:179], v232 offset:61440
    v_mfma_f32_16x16x32_bf16 v[48:51], v[200:203], v[96:99], v[48:51]
    v_cvt_pk_bf16_f32 v105, v244, v245
    ds_read_b64_tr_b16 v[180:181], v233 offset:57344
    v_exp_f32 v242, v90
    v_mfma_f32_16x16x32_bf16 v[52:55], v[200:203], v[100:103], v[52:55]
    ds_read_b64_tr_b16 v[182:183], v233 offset:61440
    v_exp_f32 v243, v91
    v_mfma_f32_16x16x32_bf16 v[56:59], v[204:207], v[96:99], v[56:59]
    ds_read_b64_tr_b16 v[184:185], v234 offset:57344
    v_mfma_f32_16x16x32_bf16 v[60:63], v[204:207], v[100:103], v[60:63]
    v_cvt_pk_bf16_f32 v106, v246, v247
    v_or3_b32 v248, v104, v105, v106
    v_mfma_f32_16x16x32_bf16 v[216:219], v[224:227], v[96:99], v[216:219]
    v_exp_f32 v244, v84
    ds_read_b64_tr_b16 v[186:187], v234 offset:61440
    v_mfma_f32_16x16x32_bf16 v[220:223], v[224:227], v[100:103], v[220:223]
    v_exp_f32 v245, v85
    ds_read_b64_tr_b16 v[188:189], v235 offset:57344
    s_waitcnt lgkmcnt(7)
    v_mfma_f32_16x16x32_bf16 v[64:67], v[144:147], v[112:115], v[208:211]
    v_cvt_pk_bf16_f32 v107, v242, v243
    ds_read_b64_tr_b16 v[190:191], v235 offset:61440
    v_mfma_f32_16x16x32_bf16 v[64:67], v[148:151], v[116:119], v[64:67]
    v_exp_f32 v246, v86
    ds_read_b64_tr_b16 v[192:193], v236 offset:57344
    s_setprio 0
    v_mfma_f32_16x16x32_bf16 v[64:67], v[152:155], v[120:123], v[64:67]
    v_exp_f32 v247, v87
    v_mfma_f32_16x16x32_bf16 v[64:67], v[156:159], v[124:127], v[64:67]
    ds_read_b64_tr_b16 v[194:195], v236 offset:61440
    v_cvt_pk_bf16_f32 v108, v244, v245
    v_or3_b32 v248, v248, v107, v108
    v_mfma_f32_16x16x32_bf16 v[68:71], v[144:147], v[128:131], v[212:215]
    v_exp_f32 v242, v92
    ds_read_b64_tr_b16 v[196:197], v237 offset:57344
    v_mfma_f32_16x16x32_bf16 v[68:71], v[148:151], v[132:135], v[68:71]
    v_exp_f32 v243, v93
    ds_read_b64_tr_b16 v[198:199], v237 offset:61440
    v_mfma_f32_16x16x32_bf16 v[68:71], v[152:155], v[136:139], v[68:71]
    v_cvt_pk_bf16_f32 v109, v246, v247
    ds_read_b64_tr_b16 v[200:201], v238 offset:57344
    v_mfma_f32_16x16x32_bf16 v[68:71], v[156:159], v[140:143], v[68:71]
    v_exp_f32 v244, v94
    v_mfma_f32_16x16x32_bf16 v[72:75], v[160:163], v[112:115], v[208:211]
    ds_read_b64_tr_b16 v[202:203], v238 offset:61440
    v_exp_f32 v245, v95
    v_mfma_f32_16x16x32_bf16 v[72:75], v[164:167], v[116:119], v[72:75]
    v_cvt_pk_bf16_f32 v110, v242, v243
    ds_read_b64_tr_b16 v[204:205], v239 offset:57344
    v_mfma_f32_16x16x32_bf16 v[72:75], v[168:171], v[120:123], v[72:75]
    v_or3_b32 v248, v248, v109, v110
    v_cvt_pk_bf16_f32 v111, v244, v245
    ds_read_b64_tr_b16 v[206:207], v239 offset:61440
    v_mfma_f32_16x16x32_bf16 v[72:75], v[172:175], v[124:127], v[72:75]
    v_or_b32 v248, v248, v111
    v_and_b32 v248, 0x40004000, v248
    v_mfma_f32_16x16x32_bf16 v[76:79], v[160:163], v[128:131], v[212:215]
    v_cmp_ne_u32 vcc, 0, v248
    v_mfma_f32_16x16x32_bf16 v[76:79], v[164:167], v[132:135], v[76:79]
    v_mfma_f32_16x16x32_bf16 v[76:79], v[168:171], v[136:139], v[76:79]
    v_mfma_f32_16x16x32_bf16 v[76:79], v[172:175], v[140:143], v[76:79]
    s_cbranch_vccnz TR_7
BK_7:
STEP_8:
    s_waitcnt vmcnt(4) lgkmcnt(0)
    s_barrier
    s_setprio 3
    v_mfma_f32_16x16x32_bf16 v[0:3], v[176:179], v[104:107], v[0:3]
    ds_read_b128 v[144:147], v228 offset:16384
    s_cmp_eq_u32 s0, 0
    s_cbranch_scc0 BU8K
    s_add_u32 m0, s72, 32768
    s_add_u32 s26, s72, 90112
    buffer_load_dwordx4 v240, s[32:35], s26 offen offset:0 nt lds
    v_xor_b32 v251, 64, v240
    buffer_load_dwordx4 v251, s[32:35], s26 offen offset:1024 nt lds
    v_xor_b32 v250, 128, v240
    buffer_load_dwordx4 v250, s[32:35], s26 offen offset:2048 nt lds
    v_xor_b32 v251, 192, v240
    buffer_load_dwordx4 v251, s[32:35], s26 offen offset:3072 nt lds
BU8K:
    v_mfma_f32_16x16x32_bf16 v[4:7], v[176:179], v[108:111], v[4:7]
    ds_read_b128 v[148:151], v229 offset:16384
    v_mfma_f32_16x16x32_bf16 v[8:11], v[180:183], v[104:107], v[8:11]
    ds_read_b128 v[152:155], v230 offset:16384
    v_mfma_f32_16x16x32_bf16 v[12:15], v[180:183], v[108:111], v[12:15]
    v_exp_f32 v242, v64
    v_mfma_f32_16x16x32_bf16 v[16:19], v[184:187], v[104:107], v[16:19]
    ds_read_b128 v[156:159], v231 offset:16384
    ds_read_b128 v[160:163], v228 offset:20480
    v_mfma_f32_16x16x32_bf16 v[20:23], v[184:187], v[108:111], v[20:23]
    v_exp_f32 v243, v65
    v_mfma_f32_16x16x32_bf16 v[24:27], v[188:191], v[104:107], v[24:27]
    v_exp_f32 v244, v66
    v_mfma_f32_16x16x32_bf16 v[28:31], v[188:191], v[108:111], v[28:31]
    ds_read_b128 v[164:167], v229 offset:20480
    ds_read_b128 v[168:171], v230 offset:20480
    v_mfma_f32_16x16x32_bf16 v[32:35], v[192:195], v[104:107], v[32:35]
    v_exp_f32 v245, v67
    v_mfma_f32_16x16x32_bf16 v[36:39], v[192:195], v[108:111], v[36:39]
    v_cvt_pk_bf16_f32 v96, v242, v243
    ds_read_b128 v[172:175], v231 offset:20480
    ds_read_b64_tr_b16 v[176:177], v232 offset:0
    v_mfma_f32_16x16x32_bf16 v[40:43], v[196:199], v[104:107], v[40:43]
    v_exp_f32 v246, v72
    v_mfma_f32_16x16x32_bf16 v[44:47], v[196:199], v[108:111], v[44:47]
    v_exp_f32 v247, v73
    ds_read_b64_tr_b16 v[178:179], v232 offset:4096
    v_mfma_f32_16x16x32_bf16 v[48:51], v[200:203], v[104:107], v[48:51]
    v_cvt_pk_bf16_f32 v97, v244, v245
    ds_read_b64_tr_b16 v[180:181], v233 offset:0
    v_exp_f32 v242, v74
    v_mfma_f32_16x16x32_bf16 v[52:55], v[200:203], v[108:111], v[52:55]
    ds_read_b64_tr_b16 v[182:183], v233 offset:4096
    v_exp_f32 v243, v75
    v_mfma_f32_16x16x32_bf16 v[56:59], v[204:207], v[104:107], v[56:59]
    ds_read_b64_tr_b16 v[184:185], v234 offset:0
    v_mfma_f32_16x16x32_bf16 v[60:63], v[204:207], v[108:111], v[60:63]
    v_cvt_pk_bf16_f32 v98, v246, v247
    v_or3_b32 v248, v96, v97, v98
    v_mfma_f32_16x16x32_bf16 v[216:219], v[224:227], v[104:107], v[216:219]
    v_exp_f32 v244, v68
    ds_read_b64_tr_b16 v[186:187], v234 offset:4096
    v_mfma_f32_16x16x32_bf16 v[220:223], v[224:227], v[108:111], v[220:223]
    v_exp_f32 v245, v69
    ds_read_b64_tr_b16 v[188:189], v235 offset:0
    s_waitcnt lgkmcnt(7)
    v_mfma_f32_16x16x32_bf16 v[80:83], v[144:147], v[112:115], v[208:211]
    v_cvt_pk_bf16_f32 v99, v242, v243
    ds_read_b64_tr_b16 v[190:191], v235 offset:4096
    v_mfma_f32_16x16x32_bf16 v[80:83], v[148:151], v[116:119], v[80:83]
    v_exp_f32 v246, v70
    ds_read_b64_tr_b16 v[192:193], v236 offset:0
    s_setprio 2
    v_mfma_f32_16x16x32_bf16 v[80:83], v[152:155], v[120:123], v[80:83]
    v_exp_f32 v247, v71
    v_mfma_f32_16x16x32_bf16 v[80:83], v[156:159], v[124:127], v[80:83]
    ds_read_b64_tr_b16 v[194:195], v236 offset:4096
    v_cvt_pk_bf16_f32 v100, v244, v245
    v_or3_b32 v248, v248, v99, v100
    v_mfma_f32_16x16x32_bf16 v[84:87], v[144:147], v[128:131], v[212:215]
    v_exp_f32 v242, v76
    ds_read_b64_tr_b16 v[196:197], v237 offset:0
    v_mfma_f32_16x16x32_bf16 v[84:87], v[148:151], v[132:135], v[84:87]
    v_exp_f32 v243, v77
    ds_read_b64_tr_b16 v[198:199], v237 offset:4096
    v_mfma_f32_16x16x32_bf16 v[84:87], v[152:155], v[136:139], v[84:87]
    v_cvt_pk_bf16_f32 v101, v246, v247
    ds_read_b64_tr_b16 v[200:201], v238 offset:0
    v_mfma_f32_16x16x32_bf16 v[84:87], v[156:159], v[140:143], v[84:87]
    v_exp_f32 v244, v78
    v_mfma_f32_16x16x32_bf16 v[88:91], v[160:163], v[112:115], v[208:211]
    ds_read_b64_tr_b16 v[202:203], v238 offset:4096
    v_exp_f32 v245, v79
    v_mfma_f32_16x16x32_bf16 v[88:91], v[164:167], v[116:119], v[88:91]
    v_cvt_pk_bf16_f32 v102, v242, v243
    ds_read_b64_tr_b16 v[204:205], v239 offset:0
    v_mfma_f32_16x16x32_bf16 v[88:91], v[168:171], v[120:123], v[88:91]
    v_or3_b32 v248, v248, v101, v102
    v_cvt_pk_bf16_f32 v103, v244, v245
    ds_read_b64_tr_b16 v[206:207], v239 offset:4096
    v_mfma_f32_16x16x32_bf16 v[88:91], v[172:175], v[124:127], v[88:91]
    v_or_b32 v248, v248, v103
    v_and_b32 v248, 0x40004000, v248
    v_mfma_f32_16x16x32_bf16 v[92:95], v[160:163], v[128:131], v[212:215]
    v_cmp_ne_u32 vcc, 0, v248
    v_mfma_f32_16x16x32_bf16 v[92:95], v[164:167], v[132:135], v[92:95]
    v_mfma_f32_16x16x32_bf16 v[92:95], v[168:171], v[136:139], v[92:95]
    v_mfma_f32_16x16x32_bf16 v[92:95], v[172:175], v[140:143], v[92:95]
    s_cbranch_vccnz TR_8
BK_8:
STEP_9:
    s_waitcnt lgkmcnt(0)
    s_setprio 1
    v_mfma_f32_16x16x32_bf16 v[0:3], v[176:179], v[96:99], v[0:3]
    ds_read_b128 v[144:147], v228 offset:24576
    s_cmp_eq_u32 s0, 0
    s_cbranch_scc0 BU9V
    s_add_u32 m0, s72, 98304
    s_add_u32 s26, s72, 98304
    buffer_load_dwordx4 v241, s[36:39], s26 offen offset:0 nt lds
    v_xor_b32 v251, 128, v241
    buffer_load_dwordx4 v251, s[36:39], s26 offen offset:1024 nt lds
    buffer_load_dwordx4 v241, s[36:39], s26 offen offset:2048 nt lds
    v_xor_b32 v251, 128, v241
    buffer_load_dwordx4 v251, s[36:39], s26 offen offset:3072 nt lds
BU9V:
    v_mfma_f32_16x16x32_bf16 v[4:7], v[176:179], v[100:103], v[4:7]
    ds_read_b128 v[148:151], v229 offset:24576
    v_mfma_f32_16x16x32_bf16 v[8:11], v[180:183], v[96:99], v[8:11]
    ds_read_b128 v[152:155], v230 offset:24576
    v_mfma_f32_16x16x32_bf16 v[12:15], v[180:183], v[100:103], v[12:15]
    v_exp_f32 v242, v80
    v_mfma_f32_16x16x32_bf16 v[16:19], v[184:187], v[96:99], v[16:19]
    ds_read_b128 v[156:159], v231 offset:24576
    ds_read_b128 v[160:163], v228 offset:28672
    v_mfma_f32_16x16x32_bf16 v[20:23], v[184:187], v[100:103], v[20:23]
    v_exp_f32 v243, v81
    v_mfma_f32_16x16x32_bf16 v[24:27], v[188:191], v[96:99], v[24:27]
    v_exp_f32 v244, v82
    v_mfma_f32_16x16x32_bf16 v[28:31], v[188:191], v[100:103], v[28:31]
    ds_read_b128 v[164:167], v229 offset:28672
    ds_read_b128 v[168:171], v230 offset:28672
    v_mfma_f32_16x16x32_bf16 v[32:35], v[192:195], v[96:99], v[32:35]
    v_exp_f32 v245, v83
    v_mfma_f32_16x16x32_bf16 v[36:39], v[192:195], v[100:103], v[36:39]
    v_cvt_pk_bf16_f32 v104, v242, v243
    ds_read_b128 v[172:175], v231 offset:28672
    ds_read_b64_tr_b16 v[176:177], v232 offset:8192
    v_mfma_f32_16x16x32_bf16 v[40:43], v[196:199], v[96:99], v[40:43]
    v_exp_f32 v246, v88
    v_mfma_f32_16x16x32_bf16 v[44:47], v[196:199], v[100:103], v[44:47]
    v_exp_f32 v247, v89
    ds_read_b64_tr_b16 v[178:179], v232 offset:12288
    v_mfma_f32_16x16x32_bf16 v[48:51], v[200:203], v[96:99], v[48:51]
    v_cvt_pk_bf16_f32 v105, v244, v245
    ds_read_b64_tr_b16 v[180:181], v233 offset:8192
    v_exp_f32 v242, v90
    v_mfma_f32_16x16x32_bf16 v[52:55], v[200:203], v[100:103], v[52:55]
    ds_read_b64_tr_b16 v[182:183], v233 offset:12288
    v_exp_f32 v243, v91
    v_mfma_f32_16x16x32_bf16 v[56:59], v[204:207], v[96:99], v[56:59]
    ds_read_b64_tr_b16 v[184:185], v234 offset:8192
    v_mfma_f32_16x16x32_bf16 v[60:63], v[204:207], v[100:103], v[60:63]
    v_cvt_pk_bf16_f32 v106, v246, v247
    v_or3_b32 v248, v104, v105, v106
    v_mfma_f32_16x16x32_bf16 v[216:219], v[224:227], v[96:99], v[216:219]
    v_exp_f32 v244, v84
    ds_read_b64_tr_b16 v[186:187], v234 offset:12288
    v_mfma_f32_16x16x32_bf16 v[220:223], v[224:227], v[100:103], v[220:223]
    v_exp_f32 v245, v85
    ds_read_b64_tr_b16 v[188:189], v235 offset:8192
    s_waitcnt lgkmcnt(7)
    v_mfma_f32_16x16x32_bf16 v[64:67], v[144:147], v[112:115], v[208:211]
    v_cvt_pk_bf16_f32 v107, v242, v243
    ds_read_b64_tr_b16 v[190:191], v235 offset:12288
    v_mfma_f32_16x16x32_bf16 v[64:67], v[148:151], v[116:119], v[64:67]
    v_exp_f32 v246, v86
    ds_read_b64_tr_b16 v[192:193], v236 offset:8192
    s_setprio 0
    v_mfma_f32_16x16x32_bf16 v[64:67], v[152:155], v[120:123], v[64:67]
    v_exp_f32 v247, v87
    v_mfma_f32_16x16x32_bf16 v[64:67], v[156:159], v[124:127], v[64:67]
    ds_read_b64_tr_b16 v[194:195], v236 offset:12288
    v_cvt_pk_bf16_f32 v108, v244, v245
    v_or3_b32 v248, v248, v107, v108
    v_mfma_f32_16x16x32_bf16 v[68:71], v[144:147], v[128:131], v[212:215]
    v_exp_f32 v242, v92
    ds_read_b64_tr_b16 v[196:197], v237 offset:8192
    v_mfma_f32_16x16x32_bf16 v[68:71], v[148:151], v[132:135], v[68:71]
    v_exp_f32 v243, v93
    ds_read_b64_tr_b16 v[198:199], v237 offset:12288
    v_mfma_f32_16x16x32_bf16 v[68:71], v[152:155], v[136:139], v[68:71]
    v_cvt_pk_bf16_f32 v109, v246, v247
    ds_read_b64_tr_b16 v[200:201], v238 offset:8192
    v_mfma_f32_16x16x32_bf16 v[68:71], v[156:159], v[140:143], v[68:71]
    v_exp_f32 v244, v94
    v_mfma_f32_16x16x32_bf16 v[72:75], v[160:163], v[112:115], v[208:211]
    ds_read_b64_tr_b16 v[202:203], v238 offset:12288
    v_exp_f32 v245, v95
    v_mfma_f32_16x16x32_bf16 v[72:75], v[164:167], v[116:119], v[72:75]
    v_cvt_pk_bf16_f32 v110, v242, v243
    ds_read_b64_tr_b16 v[204:205], v239 offset:8192
    v_mfma_f32_16x16x32_bf16 v[72:75], v[168:171], v[120:123], v[72:75]
    v_or3_b32 v248, v248, v109, v110
    v_cvt_pk_bf16_f32 v111, v244, v245
    ds_read_b64_tr_b16 v[206:207], v239 offset:12288
    v_mfma_f32_16x16x32_bf16 v[72:75], v[172:175], v[124:127], v[72:75]
    v_or_b32 v248, v248, v111
    v_and_b32 v248, 0x40004000, v248
    v_mfma_f32_16x16x32_bf16 v[76:79], v[160:163], v[128:131], v[212:215]
    v_cmp_ne_u32 vcc, 0, v248
    v_mfma_f32_16x16x32_bf16 v[76:79], v[164:167], v[132:135], v[76:79]
    v_mfma_f32_16x16x32_bf16 v[76:79], v[168:171], v[136:139], v[76:79]
    v_mfma_f32_16x16x32_bf16 v[76:79], v[172:175], v[140:143], v[76:79]
    s_cbranch_vccnz TR_9
BK_9:
STEP_10:
    s_waitcnt vmcnt(4) lgkmcnt(0)
    s_barrier
    s_setprio 3
    v_mfma_f32_16x16x32_bf16 v[0:3], v[176:179], v[104:107], v[0:3]
    ds_read_b128 v[144:147], v228 offset:32768
    s_cmp_eq_u32 s0, 0
    s_cbranch_scc0 BU10K
    s_add_u32 m0, s72, 49152
    s_add_u32 s26, s72, 106496
    buffer_load_dwordx4 v240, s[32:35], s26 offen offset:0 nt lds
    v_xor_b32 v251, 64, v240
    buffer_load_dwordx4 v251, s[32:35], s26 offen offset:1024 nt lds
    v_xor_b32 v250, 128, v240
    buffer_load_dwordx4 v250, s[32:35], s26 offen offset:2048 nt lds
    v_xor_b32 v251, 192, v240
    buffer_load_dwordx4 v251, s[32:35], s26 offen offset:3072 nt lds
BU10K:
    v_mfma_f32_16x16x32_bf16 v[4:7], v[176:179], v[108:111], v[4:7]
    ds_read_b128 v[148:151], v229 offset:32768
    v_mfma_f32_16x16x32_bf16 v[8:11], v[180:183], v[104:107], v[8:11]
    ds_read_b128 v[152:155], v230 offset:32768
    v_mfma_f32_16x16x32_bf16 v[12:15], v[180:183], v[108:111], v[12:15]
    v_exp_f32 v242, v64
    v_mfma_f32_16x16x32_bf16 v[16:19], v[184:187], v[104:107], v[16:19]
    ds_read_b128 v[156:159], v231 offset:32768
    ds_read_b128 v[160:163], v228 offset:36864
    v_mfma_f32_16x16x32_bf16 v[20:23], v[184:187], v[108:111], v[20:23]
    v_exp_f32 v243, v65
    v_mfma_f32_16x16x32_bf16 v[24:27], v[188:191], v[104:107], v[24:27]
    v_exp_f32 v244, v66
    v_mfma_f32_16x16x32_bf16 v[28:31], v[188:191], v[108:111], v[28:31]
    ds_read_b128 v[164:167], v229 offset:36864
    ds_read_b128 v[168:171], v230 offset:36864
    v_mfma_f32_16x16x32_bf16 v[32:35], v[192:195], v[104:107], v[32:35]
    v_exp_f32 v245, v67
    v_mfma_f32_16x16x32_bf16 v[36:39], v[192:195], v[108:111], v[36:39]
    v_cvt_pk_bf16_f32 v96, v242, v243
    ds_read_b128 v[172:175], v231 offset:36864
    ds_read_b64_tr_b16 v[176:177], v232 offset:16384
    v_mfma_f32_16x16x32_bf16 v[40:43], v[196:199], v[104:107], v[40:43]
    v_exp_f32 v246, v72
    v_mfma_f32_16x16x32_bf16 v[44:47], v[196:199], v[108:111], v[44:47]
    v_exp_f32 v247, v73
    ds_read_b64_tr_b16 v[178:179], v232 offset:20480
    v_mfma_f32_16x16x32_bf16 v[48:51], v[200:203], v[104:107], v[48:51]
    v_cvt_pk_bf16_f32 v97, v244, v245
    ds_read_b64_tr_b16 v[180:181], v233 offset:16384
    v_exp_f32 v242, v74
    v_mfma_f32_16x16x32_bf16 v[52:55], v[200:203], v[108:111], v[52:55]
    ds_read_b64_tr_b16 v[182:183], v233 offset:20480
    v_exp_f32 v243, v75
    v_mfma_f32_16x16x32_bf16 v[56:59], v[204:207], v[104:107], v[56:59]
    ds_read_b64_tr_b16 v[184:185], v234 offset:16384
    v_mfma_f32_16x16x32_bf16 v[60:63], v[204:207], v[108:111], v[60:63]
    v_cvt_pk_bf16_f32 v98, v246, v247
    v_or3_b32 v248, v96, v97, v98
    v_mfma_f32_16x16x32_bf16 v[216:219], v[224:227], v[104:107], v[216:219]
    v_exp_f32 v244, v68
    ds_read_b64_tr_b16 v[186:187], v234 offset:20480
    v_mfma_f32_16x16x32_bf16 v[220:223], v[224:227], v[108:111], v[220:223]
    v_exp_f32 v245, v69
    ds_read_b64_tr_b16 v[188:189], v235 offset:16384
    s_waitcnt lgkmcnt(7)
    v_mfma_f32_16x16x32_bf16 v[80:83], v[144:147], v[112:115], v[208:211]
    v_cvt_pk_bf16_f32 v99, v242, v243
    ds_read_b64_tr_b16 v[190:191], v235 offset:20480
    v_mfma_f32_16x16x32_bf16 v[80:83], v[148:151], v[116:119], v[80:83]
    v_exp_f32 v246, v70
    ds_read_b64_tr_b16 v[192:193], v236 offset:16384
    s_setprio 2
    v_mfma_f32_16x16x32_bf16 v[80:83], v[152:155], v[120:123], v[80:83]
    v_exp_f32 v247, v71
    v_mfma_f32_16x16x32_bf16 v[80:83], v[156:159], v[124:127], v[80:83]
    ds_read_b64_tr_b16 v[194:195], v236 offset:20480
    v_cvt_pk_bf16_f32 v100, v244, v245
    v_or3_b32 v248, v248, v99, v100
    v_mfma_f32_16x16x32_bf16 v[84:87], v[144:147], v[128:131], v[212:215]
    v_exp_f32 v242, v76
    ds_read_b64_tr_b16 v[196:197], v237 offset:16384
    v_mfma_f32_16x16x32_bf16 v[84:87], v[148:151], v[132:135], v[84:87]
    v_exp_f32 v243, v77
    ds_read_b64_tr_b16 v[198:199], v237 offset:20480
    v_mfma_f32_16x16x32_bf16 v[84:87], v[152:155], v[136:139], v[84:87]
    v_cvt_pk_bf16_f32 v101, v246, v247
    ds_read_b64_tr_b16 v[200:201], v238 offset:16384
    v_mfma_f32_16x16x32_bf16 v[84:87], v[156:159], v[140:143], v[84:87]
    v_exp_f32 v244, v78
    v_mfma_f32_16x16x32_bf16 v[88:91], v[160:163], v[112:115], v[208:211]
    ds_read_b64_tr_b16 v[202:203], v238 offset:20480
    v_exp_f32 v245, v79
    v_mfma_f32_16x16x32_bf16 v[88:91], v[164:167], v[116:119], v[88:91]
    v_cvt_pk_bf16_f32 v102, v242, v243
    ds_read_b64_tr_b16 v[204:205], v239 offset:16384
    v_mfma_f32_16x16x32_bf16 v[88:91], v[168:171], v[120:123], v[88:91]
    v_or3_b32 v248, v248, v101, v102
    v_cvt_pk_bf16_f32 v103, v244, v245
    ds_read_b64_tr_b16 v[206:207], v239 offset:20480
    v_mfma_f32_16x16x32_bf16 v[88:91], v[172:175], v[124:127], v[88:91]
    v_or_b32 v248, v248, v103
    v_and_b32 v248, 0x40004000, v248
    v_mfma_f32_16x16x32_bf16 v[92:95], v[160:163], v[128:131], v[212:215]
    v_cmp_ne_u32 vcc, 0, v248
    v_mfma_f32_16x16x32_bf16 v[92:95], v[164:167], v[132:135], v[92:95]
    v_mfma_f32_16x16x32_bf16 v[92:95], v[168:171], v[136:139], v[92:95]
    v_mfma_f32_16x16x32_bf16 v[92:95], v[172:175], v[140:143], v[92:95]
    s_cbranch_vccnz TR_10
BK_10:
STEP_11:
    s_waitcnt lgkmcnt(0)
    s_setprio 1
    v_mfma_f32_16x16x32_bf16 v[0:3], v[176:179], v[96:99], v[0:3]
    ds_read_b128 v[144:147], v228 offset:40960
    s_cmp_eq_u32 s0, 0
    s_cbranch_scc0 BU11V
    s_add_u32 m0, s72, 114688
    s_add_u32 s26, s72, 114688
    buffer_load_dwordx4 v241, s[36:39], s26 offen offset:0 nt lds
    v_xor_b32 v251, 128, v241
    buffer_load_dwordx4 v251, s[36:39], s26 offen offset:1024 nt lds
    buffer_load_dwordx4 v241, s[36:39], s26 offen offset:2048 nt lds
    v_xor_b32 v251, 128, v241
    buffer_load_dwordx4 v251, s[36:39], s26 offen offset:3072 nt lds
BU11V:
    v_mfma_f32_16x16x32_bf16 v[4:7], v[176:179], v[100:103], v[4:7]
    ds_read_b128 v[148:151], v229 offset:40960
    v_mfma_f32_16x16x32_bf16 v[8:11], v[180:183], v[96:99], v[8:11]
    ds_read_b128 v[152:155], v230 offset:40960
    v_mfma_f32_16x16x32_bf16 v[12:15], v[180:183], v[100:103], v[12:15]
    v_exp_f32 v242, v80
    v_mfma_f32_16x16x32_bf16 v[16:19], v[184:187], v[96:99], v[16:19]
    ds_read_b128 v[156:159], v231 offset:40960
    ds_read_b128 v[160:163], v228 offset:45056
    v_mfma_f32_16x16x32_bf16 v[20:23], v[184:187], v[100:103], v[20:23]
    v_exp_f32 v243, v81
    v_mfma_f32_16x16x32_bf16 v[24:27], v[188:191], v[96:99], v[24:27]
    v_exp_f32 v244, v82
    v_mfma_f32_16x16x32_bf16 v[28:31], v[188:191], v[100:103], v[28:31]
    ds_read_b128 v[164:167], v229 offset:45056
    ds_read_b128 v[168:171], v230 offset:45056
    v_mfma_f32_16x16x32_bf16 v[32:35], v[192:195], v[96:99], v[32:35]
    v_exp_f32 v245, v83
    v_mfma_f32_16x16x32_bf16 v[36:39], v[192:195], v[100:103], v[36:39]
    v_cvt_pk_bf16_f32 v104, v242, v243
    ds_read_b128 v[172:175], v231 offset:45056
    ds_read_b64_tr_b16 v[176:177], v232 offset:24576
    v_mfma_f32_16x16x32_bf16 v[40:43], v[196:199], v[96:99], v[40:43]
    v_exp_f32 v246, v88
    v_mfma_f32_16x16x32_bf16 v[44:47], v[196:199], v[100:103], v[44:47]
    v_exp_f32 v247, v89
    ds_read_b64_tr_b16 v[178:179], v232 offset:28672
    v_mfma_f32_16x16x32_bf16 v[48:51], v[200:203], v[96:99], v[48:51]
    v_cvt_pk_bf16_f32 v105, v244, v245
    ds_read_b64_tr_b16 v[180:181], v233 offset:24576
    v_exp_f32 v242, v90
    v_mfma_f32_16x16x32_bf16 v[52:55], v[200:203], v[100:103], v[52:55]
    ds_read_b64_tr_b16 v[182:183], v233 offset:28672
    v_exp_f32 v243, v91
    v_mfma_f32_16x16x32_bf16 v[56:59], v[204:207], v[96:99], v[56:59]
    ds_read_b64_tr_b16 v[184:185], v234 offset:24576
    v_mfma_f32_16x16x32_bf16 v[60:63], v[204:207], v[100:103], v[60:63]
    v_cvt_pk_bf16_f32 v106, v246, v247
    v_or3_b32 v248, v104, v105, v106
    v_mfma_f32_16x16x32_bf16 v[216:219], v[224:227], v[96:99], v[216:219]
    v_exp_f32 v244, v84
    ds_read_b64_tr_b16 v[186:187], v234 offset:28672
    v_mfma_f32_16x16x32_bf16 v[220:223], v[224:227], v[100:103], v[220:223]
    v_exp_f32 v245, v85
    ds_read_b64_tr_b16 v[188:189], v235 offset:24576
    s_waitcnt lgkmcnt(7)
    v_mfma_f32_16x16x32_bf16 v[64:67], v[144:147], v[112:115], v[208:211]
    v_cvt_pk_bf16_f32 v107, v242, v243
    ds_read_b64_tr_b16 v[190:191], v235 offset:28672
    v_mfma_f32_16x16x32_bf16 v[64:67], v[148:151], v[116:119], v[64:67]
    v_exp_f32 v246, v86
    ds_read_b64_tr_b16 v[192:193], v236 offset:24576
    s_setprio 0
    v_mfma_f32_16x16x32_bf16 v[64:67], v[152:155], v[120:123], v[64:67]
    v_exp_f32 v247, v87
    v_mfma_f32_16x16x32_bf16 v[64:67], v[156:159], v[124:127], v[64:67]
    ds_read_b64_tr_b16 v[194:195], v236 offset:28672
    v_cvt_pk_bf16_f32 v108, v244, v245
    v_or3_b32 v248, v248, v107, v108
    v_mfma_f32_16x16x32_bf16 v[68:71], v[144:147], v[128:131], v[212:215]
    v_exp_f32 v242, v92
    ds_read_b64_tr_b16 v[196:197], v237 offset:24576
    v_mfma_f32_16x16x32_bf16 v[68:71], v[148:151], v[132:135], v[68:71]
    v_exp_f32 v243, v93
    ds_read_b64_tr_b16 v[198:199], v237 offset:28672
    v_mfma_f32_16x16x32_bf16 v[68:71], v[152:155], v[136:139], v[68:71]
    v_cvt_pk_bf16_f32 v109, v246, v247
    ds_read_b64_tr_b16 v[200:201], v238 offset:24576
    v_mfma_f32_16x16x32_bf16 v[68:71], v[156:159], v[140:143], v[68:71]
    v_exp_f32 v244, v94
    v_mfma_f32_16x16x32_bf16 v[72:75], v[160:163], v[112:115], v[208:211]
    ds_read_b64_tr_b16 v[202:203], v238 offset:28672
    v_exp_f32 v245, v95
    v_mfma_f32_16x16x32_bf16 v[72:75], v[164:167], v[116:119], v[72:75]
    v_cvt_pk_bf16_f32 v110, v242, v243
    ds_read_b64_tr_b16 v[204:205], v239 offset:24576
    v_mfma_f32_16x16x32_bf16 v[72:75], v[168:171], v[120:123], v[72:75]
    v_or3_b32 v248, v248, v109, v110
    v_cvt_pk_bf16_f32 v111, v244, v245
    ds_read_b64_tr_b16 v[206:207], v239 offset:28672
    v_mfma_f32_16x16x32_bf16 v[72:75], v[172:175], v[124:127], v[72:75]
    v_or_b32 v248, v248, v111
    v_and_b32 v248, 0x40004000, v248
    v_mfma_f32_16x16x32_bf16 v[76:79], v[160:163], v[128:131], v[212:215]
    v_cmp_ne_u32 vcc, 0, v248
    v_mfma_f32_16x16x32_bf16 v[76:79], v[164:167], v[132:135], v[76:79]
    v_mfma_f32_16x16x32_bf16 v[76:79], v[168:171], v[136:139], v[76:79]
    v_mfma_f32_16x16x32_bf16 v[76:79], v[172:175], v[140:143], v[76:79]
    s_cbranch_vccnz TR_11
BK_11:
STEP_12:
    s_waitcnt vmcnt(4) lgkmcnt(0)
    s_barrier
    s_setprio 3
    v_mfma_f32_16x16x32_bf16 v[0:3], v[176:179], v[104:107], v[0:3]
    ds_read_b128 v[144:147], v228 offset:49152
    s_cmp_eq_u32 s0, 0
    s_cbranch_scc0 BU12K
    s_add_u32 m0, s72, 0
    s_add_u32 s26, s72, 122880
    buffer_load_dwordx4 v240, s[32:35], s26 offen offset:0 nt lds
    v_xor_b32 v251, 64, v240
    buffer_load_dwordx4 v251, s[32:35], s26 offen offset:1024 nt lds
    v_xor_b32 v250, 128, v240
    buffer_load_dwordx4 v250, s[32:35], s26 offen offset:2048 nt lds
    v_xor_b32 v251, 192, v240
    buffer_load_dwordx4 v251, s[32:35], s26 offen offset:3072 nt lds
BU12K:
    v_mfma_f32_16x16x32_bf16 v[4:7], v[176:179], v[108:111], v[4:7]
    ds_read_b128 v[148:151], v229 offset:49152
    v_mfma_f32_16x16x32_bf16 v[8:11], v[180:183], v[104:107], v[8:11]
    ds_read_b128 v[152:155], v230 offset:49152
    v_mfma_f32_16x16x32_bf16 v[12:15], v[180:183], v[108:111], v[12:15]
    v_exp_f32 v242, v64
    v_mfma_f32_16x16x32_bf16 v[16:19], v[184:187], v[104:107], v[16:19]
    ds_read_b128 v[156:159], v231 offset:49152
    ds_read_b128 v[160:163], v228 offset:53248
    v_mfma_f32_16x16x32_bf16 v[20:23], v[184:187], v[108:111], v[20:23]
    v_exp_f32 v243, v65
    v_mfma_f32_16x16x32_bf16 v[24:27], v[188:191], v[104:107], v[24:27]
    v_exp_f32 v244, v66
    v_mfma_f32_16x16x32_bf16 v[28:31], v[188:191], v[108:111], v[28:31]
    ds_read_b128 v[164:167], v229 offset:53248
    ds_read_b128 v[168:171], v230 offset:53248
    v_mfma_f32_16x16x32_bf16 v[32:35], v[192:195], v[104:107], v[32:35]
    v_exp_f32 v245, v67
    v_mfma_f32_16x16x32_bf16 v[36:39], v[192:195], v[108:111], v[36:39]
    v_cvt_pk_bf16_f32 v96, v242, v243
    ds_read_b128 v[172:175], v231 offset:53248
    ds_read_b64_tr_b16 v[176:177], v232 offset:32768
    v_mfma_f32_16x16x32_bf16 v[40:43], v[196:199], v[104:107], v[40:43]
    v_exp_f32 v246, v72
    v_mfma_f32_16x16x32_bf16 v[44:47], v[196:199], v[108:111], v[44:47]
    v_exp_f32 v247, v73
    ds_read_b64_tr_b16 v[178:179], v232 offset:36864
    v_mfma_f32_16x16x32_bf16 v[48:51], v[200:203], v[104:107], v[48:51]
    v_cvt_pk_bf16_f32 v97, v244, v245
    ds_read_b64_tr_b16 v[180:181], v233 offset:32768
    v_exp_f32 v242, v74
    v_mfma_f32_16x16x32_bf16 v[52:55], v[200:203], v[108:111], v[52:55]
    ds_read_b64_tr_b16 v[182:183], v233 offset:36864
    v_exp_f32 v243, v75
    v_mfma_f32_16x16x32_bf16 v[56:59], v[204:207], v[104:107], v[56:59]
    ds_read_b64_tr_b16 v[184:185], v234 offset:32768
    v_mfma_f32_16x16x32_bf16 v[60:63], v[204:207], v[108:111], v[60:63]
    v_cvt_pk_bf16_f32 v98, v246, v247
    v_or3_b32 v248, v96, v97, v98
    v_mfma_f32_16x16x32_bf16 v[216:219], v[224:227], v[104:107], v[216:219]
    v_exp_f32 v244, v68
    ds_read_b64_tr_b16 v[186:187], v234 offset:36864
    v_mfma_f32_16x16x32_bf16 v[220:223], v[224:227], v[108:111], v[220:223]
    v_exp_f32 v245, v69
    ds_read_b64_tr_b16 v[188:189], v235 offset:32768
    s_waitcnt lgkmcnt(7)
    v_mfma_f32_16x16x32_bf16 v[80:83], v[144:147], v[112:115], v[208:211]
    v_cvt_pk_bf16_f32 v99, v242, v243
    ds_read_b64_tr_b16 v[190:191], v235 offset:36864
    v_mfma_f32_16x16x32_bf16 v[80:83], v[148:151], v[116:119], v[80:83]
    v_exp_f32 v246, v70
    ds_read_b64_tr_b16 v[192:193], v236 offset:32768
    s_setprio 2
    v_mfma_f32_16x16x32_bf16 v[80:83], v[152:155], v[120:123], v[80:83]
    v_exp_f32 v247, v71
    v_mfma_f32_16x16x32_bf16 v[80:83], v[156:159], v[124:127], v[80:83]
    ds_read_b64_tr_b16 v[194:195], v236 offset:36864
    v_cvt_pk_bf16_f32 v100, v244, v245
    v_or3_b32 v248, v248, v99, v100
    v_mfma_f32_16x16x32_bf16 v[84:87], v[144:147], v[128:131], v[212:215]
    v_exp_f32 v242, v76
    ds_read_b64_tr_b16 v[196:197], v237 offset:32768
    v_mfma_f32_16x16x32_bf16 v[84:87], v[148:151], v[132:135], v[84:87]
    v_exp_f32 v243, v77
    ds_read_b64_tr_b16 v[198:199], v237 offset:36864
    v_mfma_f32_16x16x32_bf16 v[84:87], v[152:155], v[136:139], v[84:87]
    v_cvt_pk_bf16_f32 v101, v246, v247
    ds_read_b64_tr_b16 v[200:201], v238 offset:32768
    v_mfma_f32_16x16x32_bf16 v[84:87], v[156:159], v[140:143], v[84:87]
    v_exp_f32 v244, v78
    v_mfma_f32_16x16x32_bf16 v[88:91], v[160:163], v[112:115], v[208:211]
    ds_read_b64_tr_b16 v[202:203], v238 offset:36864
    v_exp_f32 v245, v79
    v_mfma_f32_16x16x32_bf16 v[88:91], v[164:167], v[116:119], v[88:91]
    v_cvt_pk_bf16_f32 v102, v242, v243
    ds_read_b64_tr_b16 v[204:205], v239 offset:32768
    v_mfma_f32_16x16x32_bf16 v[88:91], v[168:171], v[120:123], v[88:91]
    v_or3_b32 v248, v248, v101, v102
    v_cvt_pk_bf16_f32 v103, v244, v245
    ds_read_b64_tr_b16 v[206:207], v239 offset:36864
    v_mfma_f32_16x16x32_bf16 v[88:91], v[172:175], v[124:127], v[88:91]
    v_or_b32 v248, v248, v103
    v_and_b32 v248, 0x40004000, v248
    v_mfma_f32_16x16x32_bf16 v[92:95], v[160:163], v[128:131], v[212:215]
    v_cmp_ne_u32 vcc, 0, v248
    v_mfma_f32_16x16x32_bf16 v[92:95], v[164:167], v[132:135], v[92:95]
    v_mfma_f32_16x16x32_bf16 v[92:95], v[168:171], v[136:139], v[92:95]
    v_mfma_f32_16x16x32_bf16 v[92:95], v[172:175], v[140:143], v[92:95]
    s_cbranch_vccnz TR_12
BK_12:
STEP_13:
    s_waitcnt lgkmcnt(0)
    s_setprio 1
    v_mfma_f32_16x16x32_bf16 v[0:3], v[176:179], v[96:99], v[0:3]
    ds_read_b128 v[144:147], v228 offset:57344
    s_cmp_eq_u32 s0, 0
    s_cbranch_scc0 BU13V
    s_add_u32 m0, s72, 65536
    s_add_u32 s26, s72, 131072
    buffer_load_dwordx4 v241, s[36:39], s26 offen offset:0 nt lds
    v_xor_b32 v251, 128, v241
    buffer_load_dwordx4 v251, s[36:39], s26 offen offset:1024 nt lds
    buffer_load_dwordx4 v241, s[36:39], s26 offen offset:2048 nt lds
    v_xor_b32 v251, 128, v241
    buffer_load_dwordx4 v251, s[36:39], s26 offen offset:3072 nt lds
BU13V:
    v_mfma_f32_16x16x32_bf16 v[4:7], v[176:179], v[100:103], v[4:7]
    ds_read_b128 v[148:151], v229 offset:57344
    v_mfma_f32_16x16x32_bf16 v[8:11], v[180:183], v[96:99], v[8:11]
    ds_read_b128 v[152:155], v230 offset:57344
    v_mfma_f32_16x16x32_bf16 v[12:15], v[180:183], v[100:103], v[12:15]
    v_exp_f32 v242, v80
    v_mfma_f32_16x16x32_bf16 v[16:19], v[184:187], v[96:99], v[16:19]
    ds_read_b128 v[156:159], v231 offset:57344
    ds_read_b128 v[160:163], v228 offset:61440
    v_mfma_f32_16x16x32_bf16 v[20:23], v[184:187], v[100:103], v[20:23]
    v_exp_f32 v243, v81
    v_mfma_f32_16x16x32_bf16 v[24:27], v[188:191], v[96:99], v[24:27]
    v_exp_f32 v244, v82
    v_mfma_f32_16x16x32_bf16 v[28:31], v[188:191], v[100:103], v[28:31]
    ds_read_b128 v[164:167], v229 offset:61440
    ds_read_b128 v[168:171], v230 offset:61440
    v_mfma_f32_16x16x32_bf16 v[32:35], v[192:195], v[96:99], v[32:35]
    v_exp_f32 v245, v83
    s_cmp_lg_u32 s24, s96
    s_cbranch_scc1 SY13
    v_lshlrev_b32 v250, 8, v249
    v_mov_b32 v251, 1
    s_waitcnt vmcnt(0)
    buffer_atomic_add v251, v250, s[68:71], s75 offen sc1
SY13:
    v_mfma_f32_16x16x32_bf16 v[36:39], v[192:195], v[100:103], v[36:39]
    v_cvt_pk_bf16_f32 v104, v242, v243
    ds_read_b128 v[172:175], v231 offset:61440
    ds_read_b64_tr_b16 v[176:177], v232 offset:40960
    v_mfma_f32_16x16x32_bf16 v[40:43], v[196:199], v[96:99], v[40:43]
    v_exp_f32 v246, v88
    v_mfma_f32_16x16x32_bf16 v[44:47], v[196:199], v[100:103], v[44:47]
    v_exp_f32 v247, v89
    ds_read_b64_tr_b16 v[178:179], v232 offset:45056
    v_mfma_f32_16x16x32_bf16 v[48:51], v[200:203], v[96:99], v[48:51]
    v_cvt_pk_bf16_f32 v105, v244, v245
    ds_read_b64_tr_b16 v[180:181], v233 offset:40960
    v_exp_f32 v242, v90
    v_mfma_f32_16x16x32_bf16 v[52:55], v[200:203], v[100:103], v[52:55]
    ds_read_b64_tr_b16 v[182:183], v233 offset:45056
    v_exp_f32 v243, v91
    v_mfma_f32_16x16x32_bf16 v[56:59], v[204:207], v[96:99], v[56:59]
    ds_read_b64_tr_b16 v[184:185], v234 offset:40960
    v_mfma_f32_16x16x32_bf16 v[60:63], v[204:207], v[100:103], v[60:63]
    v_cvt_pk_bf16_f32 v106, v246, v247
    v_or3_b32 v248, v104, v105, v106
    v_mfma_f32_16x16x32_bf16 v[216:219], v[224:227], v[96:99], v[216:219]
    v_exp_f32 v244, v84
    ds_read_b64_tr_b16 v[186:187], v234 offset:45056
    v_mfma_f32_16x16x32_bf16 v[220:223], v[224:227], v[100:103], v[220:223]
    v_exp_f32 v245, v85
    ds_read_b64_tr_b16 v[188:189], v235 offset:40960
    s_waitcnt lgkmcnt(7)
    v_mfma_f32_16x16x32_bf16 v[64:67], v[144:147], v[112:115], v[208:211]
    v_cvt_pk_bf16_f32 v107, v242, v243
    ds_read_b64_tr_b16 v[190:191], v235 offset:45056
    v_mfma_f32_16x16x32_bf16 v[64:67], v[148:151], v[116:119], v[64:67]
    v_exp_f32 v246, v86
    ds_read_b64_tr_b16 v[192:193], v236 offset:40960
    s_setprio 0
    v_mfma_f32_16x16x32_bf16 v[64:67], v[152:155], v[120:123], v[64:67]
    v_exp_f32 v247, v87
    v_mfma_f32_16x16x32_bf16 v[64:67], v[156:159], v[124:127], v[64:67]
    ds_read_b64_tr_b16 v[194:195], v236 offset:45056
    v_cvt_pk_bf16_f32 v108, v244, v245
    v_or3_b32 v248, v248, v107, v108
    v_mfma_f32_16x16x32_bf16 v[68:71], v[144:147], v[128:131], v[212:215]
    v_exp_f32 v242, v92
    ds_read_b64_tr_b16 v[196:197], v237 offset:40960
    v_mfma_f32_16x16x32_bf16 v[68:71], v[148:151], v[132:135], v[68:71]
    v_exp_f32 v243, v93
    ds_read_b64_tr_b16 v[198:199], v237 offset:45056
    v_mfma_f32_16x16x32_bf16 v[68:71], v[152:155], v[136:139], v[68:71]
    v_cvt_pk_bf16_f32 v109, v246, v247
    ds_read_b64_tr_b16 v[200:201], v238 offset:40960
    v_mfma_f32_16x16x32_bf16 v[68:71], v[156:159], v[140:143], v[68:71]
    v_exp_f32 v244, v94
    v_mfma_f32_16x16x32_bf16 v[72:75], v[160:163], v[112:115], v[208:211]
    ds_read_b64_tr_b16 v[202:203], v238 offset:45056
    v_exp_f32 v245, v95
    v_mfma_f32_16x16x32_bf16 v[72:75], v[164:167], v[116:119], v[72:75]
    v_cvt_pk_bf16_f32 v110, v242, v243
    ds_read_b64_tr_b16 v[204:205], v239 offset:40960
    v_mfma_f32_16x16x32_bf16 v[72:75], v[168:171], v[120:123], v[72:75]
    v_or3_b32 v248, v248, v109, v110
    v_cvt_pk_bf16_f32 v111, v244, v245
    ds_read_b64_tr_b16 v[206:207], v239 offset:45056
    v_mfma_f32_16x16x32_bf16 v[72:75], v[172:175], v[124:127], v[72:75]
    v_or_b32 v248, v248, v111
    v_and_b32 v248, 0x40004000, v248
    v_mfma_f32_16x16x32_bf16 v[76:79], v[160:163], v[128:131], v[212:215]
    v_cmp_ne_u32 vcc, 0, v248
    v_mfma_f32_16x16x32_bf16 v[76:79], v[164:167], v[132:135], v[76:79]
    v_mfma_f32_16x16x32_bf16 v[76:79], v[168:171], v[136:139], v[76:79]
    v_mfma_f32_16x16x32_bf16 v[76:79], v[172:175], v[140:143], v[76:79]
    s_cbranch_vccnz TR_13
BK_13:
STEP_14:
    s_waitcnt vmcnt(4) lgkmcnt(0)
    s_barrier
    s_setprio 3
    v_mfma_f32_16x16x32_bf16 v[0:3], v[176:179], v[104:107], v[0:3]
    ds_read_b128 v[144:147], v228 offset:0
    s_cmp_eq_u32 s0, 0
    s_cbranch_scc0 BU14K
    s_add_u32 m0, s72, 16384
    s_add_u32 s26, s72, 139264
    buffer_load_dwordx4 v240, s[32:35], s26 offen offset:0 nt lds
    v_xor_b32 v251, 64, v240
    buffer_load_dwordx4 v251, s[32:35], s26 offen offset:1024 nt lds
    v_xor_b32 v250, 128, v240
    buffer_load_dwordx4 v250, s[32:35], s26 offen offset:2048 nt lds
    v_xor_b32 v251, 192, v240
    buffer_load_dwordx4 v251, s[32:35], s26 offen offset:3072 nt lds
BU14K:
    v_mfma_f32_16x16x32_bf16 v[4:7], v[176:179], v[108:111], v[4:7]
    ds_read_b128 v[148:151], v229 offset:0
    v_mfma_f32_16x16x32_bf16 v[8:11], v[180:183], v[104:107], v[8:11]
    ds_read_b128 v[152:155], v230 offset:0
    v_mfma_f32_16x16x32_bf16 v[12:15], v[180:183], v[108:111], v[12:15]
    v_exp_f32 v242, v64
    v_mfma_f32_16x16x32_bf16 v[16:19], v[184:187], v[104:107], v[16:19]
    ds_read_b128 v[156:159], v231 offset:0
    ds_read_b128 v[160:163], v228 offset:4096
    v_mfma_f32_16x16x32_bf16 v[20:23], v[184:187], v[108:111], v[20:23]
    v_exp_f32 v243, v65
    v_mfma_f32_16x16x32_bf16 v[24:27], v[188:191], v[104:107], v[24:27]
    v_exp_f32 v244, v66
    v_mfma_f32_16x16x32_bf16 v[28:31], v[188:191], v[108:111], v[28:31]
    ds_read_b128 v[164:167], v229 offset:4096
    ds_read_b128 v[168:171], v230 offset:4096
    v_mfma_f32_16x16x32_bf16 v[32:35], v[192:195], v[104:107], v[32:35]
    v_exp_f32 v245, v67
    v_mfma_f32_16x16x32_bf16 v[36:39], v[192:195], v[108:111], v[36:39]
    v_cvt_pk_bf16_f32 v96, v242, v243
    ds_read_b128 v[172:175], v231 offset:4096
    ds_read_b64_tr_b16 v[176:177], v232 offset:49152
    v_mfma_f32_16x16x32_bf16 v[40:43], v[196:199], v[104:107], v[40:43]
    v_exp_f32 v246, v72
    v_mfma_f32_16x16x32_bf16 v[44:47], v[196:199], v[108:111], v[44:47]
    v_exp_f32 v247, v73
    ds_read_b64_tr_b16 v[178:179], v232 offset:53248
    v_mfma_f32_16x16x32_bf16 v[48:51], v[200:203], v[104:107], v[48:51]
    v_cvt_pk_bf16_f32 v97, v244, v245
    ds_read_b64_tr_b16 v[180:181], v233 offset:49152
    v_exp_f32 v242, v74
    v_mfma_f32_16x16x32_bf16 v[52:55], v[200:203], v[108:111], v[52:55]
    ds_read_b64_tr_b16 v[182:183], v233 offset:53248
    v_exp_f32 v243, v75
    v_mfma_f32_16x16x32_bf16 v[56:59], v[204:207], v[104:107], v[56:59]
    ds_read_b64_tr_b16 v[184:185], v234 offset:49152
    v_mfma_f32_16x16x32_bf16 v[60:63], v[204:207], v[108:111], v[60:63]
    v_cvt_pk_bf16_f32 v98, v246, v247
    v_or3_b32 v248, v96, v97, v98
    v_mfma_f32_16x16x32_bf16 v[216:219], v[224:227], v[104:107], v[216:219]
    v_exp_f32 v244, v68
    ds_read_b64_tr_b16 v[186:187], v234 offset:53248
    v_mfma_f32_16x16x32_bf16 v[220:223], v[224:227], v[108:111], v[220:223]
    v_exp_f32 v245, v69
    ds_read_b64_tr_b16 v[188:189], v235 offset:49152
    s_waitcnt lgkmcnt(7)
    v_mfma_f32_16x16x32_bf16 v[80:83], v[144:147], v[112:115], v[208:211]
    v_cvt_pk_bf16_f32 v99, v242, v243
    ds_read_b64_tr_b16 v[190:191], v235 offset:53248
    v_mfma_f32_16x16x32_bf16 v[80:83], v[148:151], v[116:119], v[80:83]
    v_exp_f32 v246, v70
    ds_read_b64_tr_b16 v[192:193], v236 offset:49152
    s_setprio 2
    v_mfma_f32_16x16x32_bf16 v[80:83], v[152:155], v[120:123], v[80:83]
    v_exp_f32 v247, v71
    v_mfma_f32_16x16x32_bf16 v[80:83], v[156:159], v[124:127], v[80:83]
    ds_read_b64_tr_b16 v[194:195], v236 offset:53248
    v_cvt_pk_bf16_f32 v100, v244, v245
    v_or3_b32 v248, v248, v99, v100
    v_mfma_f32_16x16x32_bf16 v[84:87], v[144:147], v[128:131], v[212:215]
    v_exp_f32 v242, v76
    ds_read_b64_tr_b16 v[196:197], v237 offset:49152
    v_mfma_f32_16x16x32_bf16 v[84:87], v[148:151], v[132:135], v[84:87]
    v_exp_f32 v243, v77
    ds_read_b64_tr_b16 v[198:199], v237 offset:53248
    v_mfma_f32_16x16x32_bf16 v[84:87], v[152:155], v[136:139], v[84:87]
    v_cvt_pk_bf16_f32 v101, v246, v247
    ds_read_b64_tr_b16 v[200:201], v238 offset:49152
    v_mfma_f32_16x16x32_bf16 v[84:87], v[156:159], v[140:143], v[84:87]
    v_exp_f32 v244, v78
    v_mfma_f32_16x16x32_bf16 v[88:91], v[160:163], v[112:115], v[208:211]
    ds_read_b64_tr_b16 v[202:203], v238 offset:53248
    v_exp_f32 v245, v79
    v_mfma_f32_16x16x32_bf16 v[88:91], v[164:167], v[116:119], v[88:91]
    v_cvt_pk_bf16_f32 v102, v242, v243
    ds_read_b64_tr_b16 v[204:205], v239 offset:49152
    v_mfma_f32_16x16x32_bf16 v[88:91], v[168:171], v[120:123], v[88:91]
    v_or3_b32 v248, v248, v101, v102
    v_cvt_pk_bf16_f32 v103, v244, v245
    ds_read_b64_tr_b16 v[206:207], v239 offset:53248
    v_mfma_f32_16x16x32_bf16 v[88:91], v[172:175], v[124:127], v[88:91]
    v_or_b32 v248, v248, v103
    v_and_b32 v248, 0x40004000, v248
    v_mfma_f32_16x16x32_bf16 v[92:95], v[160:163], v[128:131], v[212:215]
    v_cmp_ne_u32 vcc, 0, v248
    v_mfma_f32_16x16x32_bf16 v[92:95], v[164:167], v[132:135], v[92:95]
    v_mfma_f32_16x16x32_bf16 v[92:95], v[168:171], v[136:139], v[92:95]
    v_mfma_f32_16x16x32_bf16 v[92:95], v[172:175], v[140:143], v[92:95]
    s_cbranch_vccnz TR_14
BK_14:
STEP_15:
    s_waitcnt lgkmcnt(0)
    s_setprio 1
    v_mfma_f32_16x16x32_bf16 v[0:3], v[176:179], v[96:99], v[0:3]
    ds_read_b128 v[144:147], v228 offset:8192
    s_cmp_eq_u32 s0, 0
    s_cbranch_scc0 BU15V
    s_add_u32 m0, s72, 81920
    s_add_u32 s26, s72, 147456
    buffer_load_dwordx4 v241, s[36:39], s26 offen offset:0 nt lds
    v_xor_b32 v251, 128, v241
    buffer_load_dwordx4 v251, s[36:39], s26 offen offset:1024 nt lds
    buffer_load_dwordx4 v241, s[36:39], s26 offen offset:2048 nt lds
    v_xor_b32 v251, 128, v241
    buffer_load_dwordx4 v251, s[36:39], s26 offen offset:3072 nt lds
BU15V:
    v_mfma_f32_16x16x32_bf16 v[4:7], v[176:179], v[100:103], v[4:7]
    ds_read_b128 v[148:151], v229 offset:8192
    v_mfma_f32_16x16x32_bf16 v[8:11], v[180:183], v[96:99], v[8:11]
    ds_read_b128 v[152:155], v230 offset:8192
    v_mfma_f32_16x16x32_bf16 v[12:15], v[180:183], v[100:103], v[12:15]
    v_exp_f32 v242, v80
    v_mfma_f32_16x16x32_bf16 v[16:19], v[184:187], v[96:99], v[16:19]
    ds_read_b128 v[156:159], v231 offset:8192
    ds_read_b128 v[160:163], v228 offset:12288
    v_mfma_f32_16x16x32_bf16 v[20:23], v[184:187], v[100:103], v[20:23]
    v_exp_f32 v243, v81
    v_mfma_f32_16x16x32_bf16 v[24:27], v[188:191], v[96:99], v[24:27]
    v_exp_f32 v244, v82
    v_mfma_f32_16x16x32_bf16 v[28:31], v[188:191], v[100:103], v[28:31]
    ds_read_b128 v[164:167], v229 offset:12288
    ds_read_b128 v[168:171], v230 offset:12288
    v_mfma_f32_16x16x32_bf16 v[32:35], v[192:195], v[96:99], v[32:35]
    v_exp_f32 v245, v83
    v_mfma_f32_16x16x32_bf16 v[36:39], v[192:195], v[100:103], v[36:39]
    v_cvt_pk_bf16_f32 v104, v242, v243
    ds_read_b128 v[172:175], v231 offset:12288
    ds_read_b64_tr_b16 v[176:177], v232 offset:57344
    v_mfma_f32_16x16x32_bf16 v[40:43], v[196:199], v[96:99], v[40:43]
    v_exp_f32 v246, v88
    v_mfma_f32_16x16x32_bf16 v[44:47], v[196:199], v[100:103], v[44:47]
    v_exp_f32 v247, v89
    ds_read_b64_tr_b16 v[178:179], v232 offset:61440
    v_mfma_f32_16x16x32_bf16 v[48:51], v[200:203], v[96:99], v[48:51]
    v_cvt_pk_bf16_f32 v105, v244, v245
    ds_read_b64_tr_b16 v[180:181], v233 offset:57344
    v_exp_f32 v242, v90
    v_mfma_f32_16x16x32_bf16 v[52:55], v[200:203], v[100:103], v[52:55]
    ds_read_b64_tr_b16 v[182:183], v233 offset:61440
    v_exp_f32 v243, v91
    v_mfma_f32_16x16x32_bf16 v[56:59], v[204:207], v[96:99], v[56:59]
    ds_read_b64_tr_b16 v[184:185], v234 offset:57344
    v_mfma_f32_16x16x32_bf16 v[60:63], v[204:207], v[100:103], v[60:63]
    v_cvt_pk_bf16_f32 v106, v246, v247
    v_or3_b32 v248, v104, v105, v106
    v_mfma_f32_16x16x32_bf16 v[216:219], v[224:227], v[96:99], v[216:219]
    v_exp_f32 v244, v84
    ds_read_b64_tr_b16 v[186:187], v234 offset:61440
    v_mfma_f32_16x16x32_bf16 v[220:223], v[224:227], v[100:103], v[220:223]
    v_exp_f32 v245, v85
    ds_read_b64_tr_b16 v[188:189], v235 offset:57344
    s_waitcnt lgkmcnt(7)
    v_mfma_f32_16x16x32_bf16 v[64:67], v[144:147], v[112:115], v[208:211]
    v_cvt_pk_bf16_f32 v107, v242, v243
    ds_read_b64_tr_b16 v[190:191], v235 offset:61440
    v_mfma_f32_16x16x32_bf16 v[64:67], v[148:151], v[116:119], v[64:67]
    v_exp_f32 v246, v86
    ds_read_b64_tr_b16 v[192:193], v236 offset:57344
    s_setprio 0
    v_mfma_f32_16x16x32_bf16 v[64:67], v[152:155], v[120:123], v[64:67]
    v_exp_f32 v247, v87
    v_mfma_f32_16x16x32_bf16 v[64:67], v[156:159], v[124:127], v[64:67]
    ds_read_b64_tr_b16 v[194:195], v236 offset:61440
    v_cvt_pk_bf16_f32 v108, v244, v245
    v_or3_b32 v248, v248, v107, v108
    v_mfma_f32_16x16x32_bf16 v[68:71], v[144:147], v[128:131], v[212:215]
    v_exp_f32 v242, v92
    ds_read_b64_tr_b16 v[196:197], v237 offset:57344
    v_mfma_f32_16x16x32_bf16 v[68:71], v[148:151], v[132:135], v[68:71]
    v_exp_f32 v243, v93
    ds_read_b64_tr_b16 v[198:199], v237 offset:61440
    v_mfma_f32_16x16x32_bf16 v[68:71], v[152:155], v[136:139], v[68:71]
    v_cvt_pk_bf16_f32 v109, v246, v247
    ds_read_b64_tr_b16 v[200:201], v238 offset:57344
    v_mfma_f32_16x16x32_bf16 v[68:71], v[156:159], v[140:143], v[68:71]
    v_exp_f32 v244, v94
    v_mfma_f32_16x16x32_bf16 v[72:75], v[160:163], v[112:115], v[208:211]
    ds_read_b64_tr_b16 v[202:203], v238 offset:61440
    v_exp_f32 v245, v95
    v_mfma_f32_16x16x32_bf16 v[72:75], v[164:167], v[116:119], v[72:75]
    v_cvt_pk_bf16_f32 v110, v242, v243
    ds_read_b64_tr_b16 v[204:205], v239 offset:57344
    v_mfma_f32_16x16x32_bf16 v[72:75], v[168:171], v[120:123], v[72:75]
    v_or3_b32 v248, v248, v109, v110
    v_cvt_pk_bf16_f32 v111, v244, v245
    ds_read_b64_tr_b16 v[206:207], v239 offset:61440
    v_mfma_f32_16x16x32_bf16 v[72:75], v[172:175], v[124:127], v[72:75]
    v_or_b32 v248, v248, v111
    v_and_b32 v248, 0x40004000, v248
    v_mfma_f32_16x16x32_bf16 v[76:79], v[160:163], v[128:131], v[212:215]
    v_cmp_ne_u32 vcc, 0, v248
    v_mfma_f32_16x16x32_bf16 v[76:79], v[164:167], v[132:135], v[76:79]
    v_mfma_f32_16x16x32_bf16 v[76:79], v[168:171], v[136:139], v[76:79]
    v_mfma_f32_16x16x32_bf16 v[76:79], v[172:175], v[140:143], v[76:79]
    s_cbranch_vccnz TR_15
BK_15:
STEP_16:
    s_waitcnt vmcnt(4) lgkmcnt(0)
    s_barrier
    s_setprio 3
    v_mfma_f32_16x16x32_bf16 v[0:3], v[176:179], v[104:107], v[0:3]
    ds_read_b128 v[144:147], v228 offset:16384
    s_cmp_eq_u32 s0, 0
    s_cbranch_scc0 BU16K
    s_add_u32 m0, s72, 32768
    s_add_u32 s26, s72, 155648
    buffer_load_dwordx4 v240, s[32:35], s26 offen offset:0 nt lds
    v_xor_b32 v251, 64, v240
    buffer_load_dwordx4 v251, s[32:35], s26 offen offset:1024 nt lds
    v_xor_b32 v250, 128, v240
    buffer_load_dwordx4 v250, s[32:35], s26 offen offset:2048 nt lds
    v_xor_b32 v251, 192, v240
    buffer_load_dwordx4 v251, s[32:35], s26 offen offset:3072 nt lds
BU16K:
    v_mfma_f32_16x16x32_bf16 v[4:7], v[176:179], v[108:111], v[4:7]
    ds_read_b128 v[148:151], v229 offset:16384
    v_mfma_f32_16x16x32_bf16 v[8:11], v[180:183], v[104:107], v[8:11]
    ds_read_b128 v[152:155], v230 offset:16384
    v_mfma_f32_16x16x32_bf16 v[12:15], v[180:183], v[108:111], v[12:15]
    v_exp_f32 v242, v64
    v_mfma_f32_16x16x32_bf16 v[16:19], v[184:187], v[104:107], v[16:19]
    ds_read_b128 v[156:159], v231 offset:16384
    ds_read_b128 v[160:163], v228 offset:20480
    v_mfma_f32_16x16x32_bf16 v[20:23], v[184:187], v[108:111], v[20:23]
    v_exp_f32 v243, v65
    v_mfma_f32_16x16x32_bf16 v[24:27], v[188:191], v[104:107], v[24:27]
    v_exp_f32 v244, v66
    v_mfma_f32_16x16x32_bf16 v[28:31], v[188:191], v[108:111], v[28:31]
    ds_read_b128 v[164:167], v229 offset:20480
    ds_read_b128 v[168:171], v230 offset:20480
    v_mfma_f32_16x16x32_bf16 v[32:35], v[192:195], v[104:107], v[32:35]
    v_exp_f32 v245, v67
    v_mfma_f32_16x16x32_bf16 v[36:39], v[192:195], v[108:111], v[36:39]
    v_cvt_pk_bf16_f32 v96, v242, v243
    ds_read_b128 v[172:175], v231 offset:20480
    ds_read_b64_tr_b16 v[176:177], v232 offset:0
    v_mfma_f32_16x16x32_bf16 v[40:43], v[196:199], v[104:107], v[40:43]
    v_exp_f32 v246, v72
    v_mfma_f32_16x16x32_bf16 v[44:47], v[196:199], v[108:111], v[44:47]
    v_exp_f32 v247, v73
    ds_read_b64_tr_b16 v[178:179], v232 offset:4096
    v_mfma_f32_16x16x32_bf16 v[48:51], v[200:203], v[104:107], v[48:51]
    v_cvt_pk_bf16_f32 v97, v244, v245
    ds_read_b64_tr_b16 v[180:181], v233 offset:0
    v_exp_f32 v242, v74
    v_mfma_f32_16x16x32_bf16 v[52:55], v[200:203], v[108:111], v[52:55]
    ds_read_b64_tr_b16 v[182:183], v233 offset:4096
    v_exp_f32 v243, v75
    v_mfma_f32_16x16x32_bf16 v[56:59], v[204:207], v[104:107], v[56:59]
    ds_read_b64_tr_b16 v[184:185], v234 offset:0
    v_mfma_f32_16x16x32_bf16 v[60:63], v[204:207], v[108:111], v[60:63]
    v_cvt_pk_bf16_f32 v98, v246, v247
    v_or3_b32 v248, v96, v97, v98
    v_mfma_f32_16x16x32_bf16 v[216:219], v[224:227], v[104:107], v[216:219]
    v_exp_f32 v244, v68
    ds_read_b64_tr_b16 v[186:187], v234 offset:4096
    v_mfma_f32_16x16x32_bf16 v[220:223], v[224:227], v[108:111], v[220:223]
    v_exp_f32 v245, v69
    ds_read_b64_tr_b16 v[188:189], v235 offset:0
    s_waitcnt lgkmcnt(7)
    v_mfma_f32_16x16x32_bf16 v[80:83], v[144:147], v[112:115], v[208:211]
    v_cvt_pk_bf16_f32 v99, v242, v243
    ds_read_b64_tr_b16 v[190:191], v235 offset:4096
    v_mfma_f32_16x16x32_bf16 v[80:83], v[148:151], v[116:119], v[80:83]
    v_exp_f32 v246, v70
    ds_read_b64_tr_b16 v[192:193], v236 offset:0
    s_setprio 2
    v_mfma_f32_16x16x32_bf16 v[80:83], v[152:155], v[120:123], v[80:83]
    v_exp_f32 v247, v71
    v_mfma_f32_16x16x32_bf16 v[80:83], v[156:159], v[124:127], v[80:83]
    ds_read_b64_tr_b16 v[194:195], v236 offset:4096
    v_cvt_pk_bf16_f32 v100, v244, v245
    v_or3_b32 v248, v248, v99, v100
    v_mfma_f32_16x16x32_bf16 v[84:87], v[144:147], v[128:131], v[212:215]
    v_exp_f32 v242, v76
    ds_read_b64_tr_b16 v[196:197], v237 offset:0
    v_mfma_f32_16x16x32_bf16 v[84:87], v[148:151], v[132:135], v[84:87]
    v_exp_f32 v243, v77
    ds_read_b64_tr_b16 v[198:199], v237 offset:4096
    v_mfma_f32_16x16x32_bf16 v[84:87], v[152:155], v[136:139], v[84:87]
    v_cvt_pk_bf16_f32 v101, v246, v247
    ds_read_b64_tr_b16 v[200:201], v238 offset:0
    v_mfma_f32_16x16x32_bf16 v[84:87], v[156:159], v[140:143], v[84:87]
    v_exp_f32 v244, v78
    v_mfma_f32_16x16x32_bf16 v[88:91], v[160:163], v[112:115], v[208:211]
    ds_read_b64_tr_b16 v[202:203], v238 offset:4096
    v_exp_f32 v245, v79
    v_mfma_f32_16x16x32_bf16 v[88:91], v[164:167], v[116:119], v[88:91]
    v_cvt_pk_bf16_f32 v102, v242, v243
    ds_read_b64_tr_b16 v[204:205], v239 offset:0
    v_mfma_f32_16x16x32_bf16 v[88:91], v[168:171], v[120:123], v[88:91]
    v_or3_b32 v248, v248, v101, v102
    v_cvt_pk_bf16_f32 v103, v244, v245
    ds_read_b64_tr_b16 v[206:207], v239 offset:4096
    v_mfma_f32_16x16x32_bf16 v[88:91], v[172:175], v[124:127], v[88:91]
    v_or_b32 v248, v248, v103
    v_and_b32 v248, 0x40004000, v248
    v_mfma_f32_16x16x32_bf16 v[92:95], v[160:163], v[128:131], v[212:215]
    v_cmp_ne_u32 vcc, 0, v248
    v_mfma_f32_16x16x32_bf16 v[92:95], v[164:167], v[132:135], v[92:95]
    v_mfma_f32_16x16x32_bf16 v[92:95], v[168:171], v[136:139], v[92:95]
    v_mfma_f32_16x16x32_bf16 v[92:95], v[172:175], v[140:143], v[92:95]
    s_cbranch_vccnz TR_16
BK_16:
STEP_17:
    s_waitcnt lgkmcnt(0)
    s_setprio 1
    v_mfma_f32_16x16x32_bf16 v[0:3], v[176:179], v[96:99], v[0:3]
    ds_read_b128 v[144:147], v228 offset:24576
    s_cmp_eq_u32 s0, 0
    s_cbranch_scc0 BU17V
    s_add_u32 m0, s72, 98304
    s_add_u32 s26, s72, 163840
    buffer_load_dwordx4 v241, s[36:39], s26 offen offset:0 nt lds
    v_xor_b32 v251, 128, v241
    buffer_load_dwordx4 v251, s[36:39], s26 offen offset:1024 nt lds
    buffer_load_dwordx4 v241, s[36:39], s26 offen offset:2048 nt lds
    v_xor_b32 v251, 128, v241
    buffer_load_dwordx4 v251, s[36:39], s26 offen offset:3072 nt lds
BU17V:
    v_mfma_f32_16x16x32_bf16 v[4:7], v[176:179], v[100:103], v[4:7]
    ds_read_b128 v[148:151], v229 offset:24576
    v_mfma_f32_16x16x32_bf16 v[8:11], v[180:183], v[96:99], v[8:11]
    ds_read_b128 v[152:155], v230 offset:24576
    v_mfma_f32_16x16x32_bf16 v[12:15], v[180:183], v[100:103], v[12:15]
    v_exp_f32 v242, v80
    v_mfma_f32_16x16x32_bf16 v[16:19], v[184:187], v[96:99], v[16:19]
    ds_read_b128 v[156:159], v231 offset:24576
    ds_read_b128 v[160:163], v228 offset:28672
    v_mfma_f32_16x16x32_bf16 v[20:23], v[184:187], v[100:103], v[20:23]
    v_exp_f32 v243, v81
    v_mfma_f32_16x16x32_bf16 v[24:27], v[188:191], v[96:99], v[24:27]
    v_exp_f32 v244, v82
    v_mfma_f32_16x16x32_bf16 v[28:31], v[188:191], v[100:103], v[28:31]
    ds_read_b128 v[164:167], v229 offset:28672
    ds_read_b128 v[168:171], v230 offset:28672
    v_mfma_f32_16x16x32_bf16 v[32:35], v[192:195], v[96:99], v[32:35]
    v_exp_f32 v245, v83
    v_mfma_f32_16x16x32_bf16 v[36:39], v[192:195], v[100:103], v[36:39]
    v_cvt_pk_bf16_f32 v104, v242, v243
    ds_read_b128 v[172:175], v231 offset:28672
    ds_read_b64_tr_b16 v[176:177], v232 offset:8192
    v_mfma_f32_16x16x32_bf16 v[40:43], v[196:199], v[96:99], v[40:43]
    v_exp_f32 v246, v88
    v_mfma_f32_16x16x32_bf16 v[44:47], v[196:199], v[100:103], v[44:47]
    v_exp_f32 v247, v89
    ds_read_b64_tr_b16 v[178:179], v232 offset:12288
    v_mfma_f32_16x16x32_bf16 v[48:51], v[200:203], v[96:99], v[48:51]
    v_cvt_pk_bf16_f32 v105, v244, v245
    ds_read_b64_tr_b16 v[180:181], v233 offset:8192
    v_exp_f32 v242, v90
    v_mfma_f32_16x16x32_bf16 v[52:55], v[200:203], v[100:103], v[52:55]
    ds_read_b64_tr_b16 v[182:183], v233 offset:12288
    v_exp_f32 v243, v91
    v_mfma_f32_16x16x32_bf16 v[56:59], v[204:207], v[96:99], v[56:59]
    ds_read_b64_tr_b16 v[184:185], v234 offset:8192
    v_mfma_f32_16x16x32_bf16 v[60:63], v[204:207], v[100:103], v[60:63]
    v_cvt_pk_bf16_f32 v106, v246, v247
    v_or3_b32 v248, v104, v105, v106
    v_mfma_f32_16x16x32_bf16 v[216:219], v[224:227], v[96:99], v[216:219]
    v_exp_f32 v244, v84
    ds_read_b64_tr_b16 v[186:187], v234 offset:12288
    v_mfma_f32_16x16x32_bf16 v[220:223], v[224:227], v[100:103], v[220:223]
    v_exp_f32 v245, v85
    ds_read_b64_tr_b16 v[188:189], v235 offset:8192
    s_waitcnt lgkmcnt(7)
    v_mfma_f32_16x16x32_bf16 v[64:67], v[144:147], v[112:115], v[208:211]
    v_cvt_pk_bf16_f32 v107, v242, v243
    ds_read_b64_tr_b16 v[190:191], v235 offset:12288
    v_mfma_f32_16x16x32_bf16 v[64:67], v[148:151], v[116:119], v[64:67]
    v_exp_f32 v246, v86
    ds_read_b64_tr_b16 v[192:193], v236 offset:8192
    s_setprio 0
    v_mfma_f32_16x16x32_bf16 v[64:67], v[152:155], v[120:123], v[64:67]
    v_exp_f32 v247, v87
    v_mfma_f32_16x16x32_bf16 v[64:67], v[156:159], v[124:127], v[64:67]
    ds_read_b64_tr_b16 v[194:195], v236 offset:12288
    v_cvt_pk_bf16_f32 v108, v244, v245
    v_or3_b32 v248, v248, v107, v108
    v_mfma_f32_16x16x32_bf16 v[68:71], v[144:147], v[128:131], v[212:215]
    v_exp_f32 v242, v92
    ds_read_b64_tr_b16 v[196:197], v237 offset:8192
    v_mfma_f32_16x16x32_bf16 v[68:71], v[148:151], v[132:135], v[68:71]
    v_exp_f32 v243, v93
    ds_read_b64_tr_b16 v[198:199], v237 offset:12288
    v_mfma_f32_16x16x32_bf16 v[68:71], v[152:155], v[136:139], v[68:71]
    v_cvt_pk_bf16_f32 v109, v246, v247
    ds_read_b64_tr_b16 v[200:201], v238 offset:8192
    v_mfma_f32_16x16x32_bf16 v[68:71], v[156:159], v[140:143], v[68:71]
    v_exp_f32 v244, v94
    v_mfma_f32_16x16x32_bf16 v[72:75], v[160:163], v[112:115], v[208:211]
    ds_read_b64_tr_b16 v[202:203], v238 offset:12288
    v_exp_f32 v245, v95
    v_mfma_f32_16x16x32_bf16 v[72:75], v[164:167], v[116:119], v[72:75]
    v_cvt_pk_bf16_f32 v110, v242, v243
    ds_read_b64_tr_b16 v[204:205], v239 offset:8192
    v_mfma_f32_16x16x32_bf16 v[72:75], v[168:171], v[120:123], v[72:75]
    v_or3_b32 v248, v248, v109, v110
    v_cvt_pk_bf16_f32 v111, v244, v245
    ds_read_b64_tr_b16 v[206:207], v239 offset:12288
    v_mfma_f32_16x16x32_bf16 v[72:75], v[172:175], v[124:127], v[72:75]
    v_or_b32 v248, v248, v111
    v_and_b32 v248, 0x40004000, v248
    v_mfma_f32_16x16x32_bf16 v[76:79], v[160:163], v[128:131], v[212:215]
    v_cmp_ne_u32 vcc, 0, v248
    v_mfma_f32_16x16x32_bf16 v[76:79], v[164:167], v[132:135], v[76:79]
    v_mfma_f32_16x16x32_bf16 v[76:79], v[168:171], v[136:139], v[76:79]
    v_mfma_f32_16x16x32_bf16 v[76:79], v[172:175], v[140:143], v[76:79]
    s_cbranch_vccnz TR_17
BK_17:
STEP_18:
    s_waitcnt vmcnt(4) lgkmcnt(0)
    s_barrier
    s_setprio 3
    v_mfma_f32_16x16x32_bf16 v[0:3], v[176:179], v[104:107], v[0:3]
    ds_read_b128 v[144:147], v228 offset:32768
    s_cmp_eq_u32 s0, 0
    s_cbranch_scc0 BU18K
    s_add_u32 m0, s72, 49152
    s_add_u32 s26, s72, 172032
    buffer_load_dwordx4 v240, s[32:35], s26 offen offset:0 nt lds
    v_xor_b32 v251, 64, v240
    buffer_load_dwordx4 v251, s[32:35], s26 offen offset:1024 nt lds
    v_xor_b32 v250, 128, v240
    buffer_load_dwordx4 v250, s[32:35], s26 offen offset:2048 nt lds
    v_xor_b32 v251, 192, v240
    buffer_load_dwordx4 v251, s[32:35], s26 offen offset:3072 nt lds
BU18K:
    v_mfma_f32_16x16x32_bf16 v[4:7], v[176:179], v[108:111], v[4:7]
    ds_read_b128 v[148:151], v229 offset:32768
    v_mfma_f32_16x16x32_bf16 v[8:11], v[180:183], v[104:107], v[8:11]
    ds_read_b128 v[152:155], v230 offset:32768
    v_mfma_f32_16x16x32_bf16 v[12:15], v[180:183], v[108:111], v[12:15]
    v_exp_f32 v242, v64
    v_mfma_f32_16x16x32_bf16 v[16:19], v[184:187], v[104:107], v[16:19]
    ds_read_b128 v[156:159], v231 offset:32768
    ds_read_b128 v[160:163], v228 offset:36864
    v_mfma_f32_16x16x32_bf16 v[20:23], v[184:187], v[108:111], v[20:23]
    v_exp_f32 v243, v65
    v_mfma_f32_16x16x32_bf16 v[24:27], v[188:191], v[104:107], v[24:27]
    v_exp_f32 v244, v66
    v_mfma_f32_16x16x32_bf16 v[28:31], v[188:191], v[108:111], v[28:31]
    ds_read_b128 v[164:167], v229 offset:36864
    ds_read_b128 v[168:171], v230 offset:36864
    v_mfma_f32_16x16x32_bf16 v[32:35], v[192:195], v[104:107], v[32:35]
    v_exp_f32 v245, v67
    v_mfma_f32_16x16x32_bf16 v[36:39], v[192:195], v[108:111], v[36:39]
    v_cvt_pk_bf16_f32 v96, v242, v243
    ds_read_b128 v[172:175], v231 offset:36864
    ds_read_b64_tr_b16 v[176:177], v232 offset:16384
    v_mfma_f32_16x16x32_bf16 v[40:43], v[196:199], v[104:107], v[40:43]
    v_exp_f32 v246, v72
    v_mfma_f32_16x16x32_bf16 v[44:47], v[196:199], v[108:111], v[44:47]
    v_exp_f32 v247, v73
    ds_read_b64_tr_b16 v[178:179], v232 offset:20480
    v_mfma_f32_16x16x32_bf16 v[48:51], v[200:203], v[104:107], v[48:51]
    v_cvt_pk_bf16_f32 v97, v244, v245
    ds_read_b64_tr_b16 v[180:181], v233 offset:16384
    v_exp_f32 v242, v74
    v_mfma_f32_16x16x32_bf16 v[52:55], v[200:203], v[108:111], v[52:55]
    ds_read_b64_tr_b16 v[182:183], v233 offset:20480
    v_exp_f32 v243, v75
    v_mfma_f32_16x16x32_bf16 v[56:59], v[204:207], v[104:107], v[56:59]
    ds_read_b64_tr_b16 v[184:185], v234 offset:16384
    v_mfma_f32_16x16x32_bf16 v[60:63], v[204:207], v[108:111], v[60:63]
    v_cvt_pk_bf16_f32 v98, v246, v247
    v_or3_b32 v248, v96, v97, v98
    v_mfma_f32_16x16x32_bf16 v[216:219], v[224:227], v[104:107], v[216:219]
    v_exp_f32 v244, v68
    ds_read_b64_tr_b16 v[186:187], v234 offset:20480
    v_mfma_f32_16x16x32_bf16 v[220:223], v[224:227], v[108:111], v[220:223]
    v_exp_f32 v245, v69
    ds_read_b64_tr_b16 v[188:189], v235 offset:16384
    s_waitcnt lgkmcnt(7)
    v_mfma_f32_16x16x32_bf16 v[80:83], v[144:147], v[112:115], v[208:211]
    v_cvt_pk_bf16_f32 v99, v242, v243
    ds_read_b64_tr_b16 v[190:191], v235 offset:20480
    v_mfma_f32_16x16x32_bf16 v[80:83], v[148:151], v[116:119], v[80:83]
    v_exp_f32 v246, v70
    ds_read_b64_tr_b16 v[192:193], v236 offset:16384
    s_setprio 2
    v_mfma_f32_16x16x32_bf16 v[80:83], v[152:155], v[120:123], v[80:83]
    v_exp_f32 v247, v71
    v_mfma_f32_16x16x32_bf16 v[80:83], v[156:159], v[124:127], v[80:83]
    ds_read_b64_tr_b16 v[194:195], v236 offset:20480
    v_cvt_pk_bf16_f32 v100, v244, v245
    v_or3_b32 v248, v248, v99, v100
    v_mfma_f32_16x16x32_bf16 v[84:87], v[144:147], v[128:131], v[212:215]
    v_exp_f32 v242, v76
    ds_read_b64_tr_b16 v[196:197], v237 offset:16384
    v_mfma_f32_16x16x32_bf16 v[84:87], v[148:151], v[132:135], v[84:87]
    v_exp_f32 v243, v77
    ds_read_b64_tr_b16 v[198:199], v237 offset:20480
    v_mfma_f32_16x16x32_bf16 v[84:87], v[152:155], v[136:139], v[84:87]
    v_cvt_pk_bf16_f32 v101, v246, v247
    ds_read_b64_tr_b16 v[200:201], v238 offset:16384
    v_mfma_f32_16x16x32_bf16 v[84:87], v[156:159], v[140:143], v[84:87]
    v_exp_f32 v244, v78
    v_mfma_f32_16x16x32_bf16 v[88:91], v[160:163], v[112:115], v[208:211]
    ds_read_b64_tr_b16 v[202:203], v238 offset:20480
    v_exp_f32 v245, v79
    v_mfma_f32_16x16x32_bf16 v[88:91], v[164:167], v[116:119], v[88:91]
    v_cvt_pk_bf16_f32 v102, v242, v243
    ds_read_b64_tr_b16 v[204:205], v239 offset:16384
    v_mfma_f32_16x16x32_bf16 v[88:91], v[168:171], v[120:123], v[88:91]
    v_or3_b32 v248, v248, v101, v102
    v_cvt_pk_bf16_f32 v103, v244, v245
    ds_read_b64_tr_b16 v[206:207], v239 offset:20480
    v_mfma_f32_16x16x32_bf16 v[88:91], v[172:175], v[124:127], v[88:91]
    v_or_b32 v248, v248, v103
    v_and_b32 v248, 0x40004000, v248
    v_mfma_f32_16x16x32_bf16 v[92:95], v[160:163], v[128:131], v[212:215]
    v_cmp_ne_u32 vcc, 0, v248
    v_mfma_f32_16x16x32_bf16 v[92:95], v[164:167], v[132:135], v[92:95]
    v_mfma_f32_16x16x32_bf16 v[92:95], v[168:171], v[136:139], v[92:95]
    v_mfma_f32_16x16x32_bf16 v[92:95], v[172:175], v[140:143], v[92:95]
    s_cbranch_vccnz TR_18
BK_18:
STEP_19:
    s_waitcnt lgkmcnt(0)
    s_setprio 1
    v_mfma_f32_16x16x32_bf16 v[0:3], v[176:179], v[96:99], v[0:3]
    ds_read_b128 v[144:147], v228 offset:40960
    s_cmp_eq_u32 s0, 0
    s_cbranch_scc0 BU19V
    s_add_u32 m0, s72, 114688
    s_add_u32 s26, s72, 180224
    buffer_load_dwordx4 v241, s[36:39], s26 offen offset:0 nt lds
    v_xor_b32 v251, 128, v241
    buffer_load_dwordx4 v251, s[36:39], s26 offen offset:1024 nt lds
    buffer_load_dwordx4 v241, s[36:39], s26 offen offset:2048 nt lds
    v_xor_b32 v251, 128, v241
    buffer_load_dwordx4 v251, s[36:39], s26 offen offset:3072 nt lds
BU19V:
    v_mfma_f32_16x16x32_bf16 v[4:7], v[176:179], v[100:103], v[4:7]
    ds_read_b128 v[148:151], v229 offset:40960
    v_mfma_f32_16x16x32_bf16 v[8:11], v[180:183], v[96:99], v[8:11]
    ds_read_b128 v[152:155], v230 offset:40960
    v_mfma_f32_16x16x32_bf16 v[12:15], v[180:183], v[100:103], v[12:15]
    v_exp_f32 v242, v80
    v_mfma_f32_16x16x32_bf16 v[16:19], v[184:187], v[96:99], v[16:19]
    ds_read_b128 v[156:159], v231 offset:40960
    ds_read_b128 v[160:163], v228 offset:45056
    v_mfma_f32_16x16x32_bf16 v[20:23], v[184:187], v[100:103], v[20:23]
    v_exp_f32 v243, v81
    v_mfma_f32_16x16x32_bf16 v[24:27], v[188:191], v[96:99], v[24:27]
    v_exp_f32 v244, v82
    v_mfma_f32_16x16x32_bf16 v[28:31], v[188:191], v[100:103], v[28:31]
    ds_read_b128 v[164:167], v229 offset:45056
    ds_read_b128 v[168:171], v230 offset:45056
    v_mfma_f32_16x16x32_bf16 v[32:35], v[192:195], v[96:99], v[32:35]
    v_exp_f32 v245, v83
    s_cmp_lg_u32 s24, s96
    s_cbranch_scc1 SY19
    buffer_load_dword v254, off, s[68:71], s75
SY19:
    v_mfma_f32_16x16x32_bf16 v[36:39], v[192:195], v[100:103], v[36:39]
    v_cvt_pk_bf16_f32 v104, v242, v243
    ds_read_b128 v[172:175], v231 offset:45056
    ds_read_b64_tr_b16 v[176:177], v232 offset:24576
    v_mfma_f32_16x16x32_bf16 v[40:43], v[196:199], v[96:99], v[40:43]
    v_exp_f32 v246, v88
    v_mfma_f32_16x16x32_bf16 v[44:47], v[196:199], v[100:103], v[44:47]
    v_exp_f32 v247, v89
    ds_read_b64_tr_b16 v[178:179], v232 offset:28672
    v_mfma_f32_16x16x32_bf16 v[48:51], v[200:203], v[96:99], v[48:51]
    v_cvt_pk_bf16_f32 v105, v244, v245
    ds_read_b64_tr_b16 v[180:181], v233 offset:24576
    v_exp_f32 v242, v90
    v_mfma_f32_16x16x32_bf16 v[52:55], v[200:203], v[100:103], v[52:55]
    ds_read_b64_tr_b16 v[182:183], v233 offset:28672
    v_exp_f32 v243, v91
    v_mfma_f32_16x16x32_bf16 v[56:59], v[204:207], v[96:99], v[56:59]
    ds_read_b64_tr_b16 v[184:185], v234 offset:24576
    v_mfma_f32_16x16x32_bf16 v[60:63], v[204:207], v[100:103], v[60:63]
    v_cvt_pk_bf16_f32 v106, v246, v247
    v_or3_b32 v248, v104, v105, v106
    v_mfma_f32_16x16x32_bf16 v[216:219], v[224:227], v[96:99], v[216:219]
    v_exp_f32 v244, v84
    ds_read_b64_tr_b16 v[186:187], v234 offset:28672
    v_mfma_f32_16x16x32_bf16 v[220:223], v[224:227], v[100:103], v[220:223]
    v_exp_f32 v245, v85
    ds_read_b64_tr_b16 v[188:189], v235 offset:24576
    s_waitcnt lgkmcnt(7)
    v_mfma_f32_16x16x32_bf16 v[64:67], v[144:147], v[112:115], v[208:211]
    v_cvt_pk_bf16_f32 v107, v242, v243
    ds_read_b64_tr_b16 v[190:191], v235 offset:28672
    v_mfma_f32_16x16x32_bf16 v[64:67], v[148:151], v[116:119], v[64:67]
    v_exp_f32 v246, v86
    ds_read_b64_tr_b16 v[192:193], v236 offset:24576
    s_setprio 0
    v_mfma_f32_16x16x32_bf16 v[64:67], v[152:155], v[120:123], v[64:67]
    v_exp_f32 v247, v87
    v_mfma_f32_16x16x32_bf16 v[64:67], v[156:159], v[124:127], v[64:67]
    ds_read_b64_tr_b16 v[194:195], v236 offset:28672
    v_cvt_pk_bf16_f32 v108, v244, v245
    v_or3_b32 v248, v248, v107, v108
    v_mfma_f32_16x16x32_bf16 v[68:71], v[144:147], v[128:131], v[212:215]
    v_exp_f32 v242, v92
    ds_read_b64_tr_b16 v[196:197], v237 offset:24576
    v_mfma_f32_16x16x32_bf16 v[68:71], v[148:151], v[132:135], v[68:71]
    v_exp_f32 v243, v93
    ds_read_b64_tr_b16 v[198:199], v237 offset:28672
    v_mfma_f32_16x16x32_bf16 v[68:71], v[152:155], v[136:139], v[68:71]
    v_cvt_pk_bf16_f32 v109, v246, v247
    ds_read_b64_tr_b16 v[200:201], v238 offset:24576
    v_mfma_f32_16x16x32_bf16 v[68:71], v[156:159], v[140:143], v[68:71]
    v_exp_f32 v244, v94
    v_mfma_f32_16x16x32_bf16 v[72:75], v[160:163], v[112:115], v[208:211]
    ds_read_b64_tr_b16 v[202:203], v238 offset:28672
    v_exp_f32 v245, v95
    v_mfma_f32_16x16x32_bf16 v[72:75], v[164:167], v[116:119], v[72:75]
    v_cvt_pk_bf16_f32 v110, v242, v243
    ds_read_b64_tr_b16 v[204:205], v239 offset:24576
    v_mfma_f32_16x16x32_bf16 v[72:75], v[168:171], v[120:123], v[72:75]
    v_or3_b32 v248, v248, v109, v110
    v_cvt_pk_bf16_f32 v111, v244, v245
    ds_read_b64_tr_b16 v[206:207], v239 offset:28672
    v_mfma_f32_16x16x32_bf16 v[72:75], v[172:175], v[124:127], v[72:75]
    v_or_b32 v248, v248, v111
    v_and_b32 v248, 0x40004000, v248
    v_mfma_f32_16x16x32_bf16 v[76:79], v[160:163], v[128:131], v[212:215]
    v_cmp_ne_u32 vcc, 0, v248
    v_mfma_f32_16x16x32_bf16 v[76:79], v[164:167], v[132:135], v[76:79]
    v_mfma_f32_16x16x32_bf16 v[76:79], v[168:171], v[136:139], v[76:79]
    v_mfma_f32_16x16x32_bf16 v[76:79], v[172:175], v[140:143], v[76:79]
    s_cbranch_vccnz TR_19
BK_19:
STEP_20:
    s_waitcnt vmcnt(4) lgkmcnt(0)
    s_barrier
    s_setprio 3
    v_mfma_f32_16x16x32_bf16 v[0:3], v[176:179], v[104:107], v[0:3]
    ds_read_b128 v[144:147], v228 offset:49152
    s_cmp_eq_u32 s0, 0
    s_cbranch_scc0 BU20K
    s_add_u32 m0, s72, 0
    s_add_u32 s26, s72, 188416
    buffer_load_dwordx4 v240, s[32:35], s26 offen offset:0 nt lds
    v_xor_b32 v251, 64, v240
    buffer_load_dwordx4 v251, s[32:35], s26 offen offset:1024 nt lds
    v_xor_b32 v250, 128, v240
    buffer_load_dwordx4 v250, s[32:35], s26 offen offset:2048 nt lds
    v_xor_b32 v251, 192, v240
    buffer_load_dwordx4 v251, s[32:35], s26 offen offset:3072 nt lds
BU20K:
    v_mfma_f32_16x16x32_bf16 v[4:7], v[176:179], v[108:111], v[4:7]
    ds_read_b128 v[148:151], v229 offset:49152
    v_mfma_f32_16x16x32_bf16 v[8:11], v[180:183], v[104:107], v[8:11]
    ds_read_b128 v[152:155], v230 offset:49152
    v_mfma_f32_16x16x32_bf16 v[12:15], v[180:183], v[108:111], v[12:15]
    v_exp_f32 v242, v64
    v_mfma_f32_16x16x32_bf16 v[16:19], v[184:187], v[104:107], v[16:19]
    ds_read_b128 v[156:159], v231 offset:49152
    ds_read_b128 v[160:163], v228 offset:53248
    v_mfma_f32_16x16x32_bf16 v[20:23], v[184:187], v[108:111], v[20:23]
    v_exp_f32 v243, v65
    v_mfma_f32_16x16x32_bf16 v[24:27], v[188:191], v[104:107], v[24:27]
    v_exp_f32 v244, v66
    v_mfma_f32_16x16x32_bf16 v[28:31], v[188:191], v[108:111], v[28:31]
    ds_read_b128 v[164:167], v229 offset:53248
    ds_read_b128 v[168:171], v230 offset:53248
    v_mfma_f32_16x16x32_bf16 v[32:35], v[192:195], v[104:107], v[32:35]
    v_exp_f32 v245, v67
    v_mfma_f32_16x16x32_bf16 v[36:39], v[192:195], v[108:111], v[36:39]
    v_cvt_pk_bf16_f32 v96, v242, v243
    ds_read_b128 v[172:175], v231 offset:53248
    ds_read_b64_tr_b16 v[176:177], v232 offset:32768
    v_mfma_f32_16x16x32_bf16 v[40:43], v[196:199], v[104:107], v[40:43]
    v_exp_f32 v246, v72
    v_mfma_f32_16x16x32_bf16 v[44:47], v[196:199], v[108:111], v[44:47]
    v_exp_f32 v247, v73
    ds_read_b64_tr_b16 v[178:179], v232 offset:36864
    v_mfma_f32_16x16x32_bf16 v[48:51], v[200:203], v[104:107], v[48:51]
    v_cvt_pk_bf16_f32 v97, v244, v245
    ds_read_b64_tr_b16 v[180:181], v233 offset:32768
    v_exp_f32 v242, v74
    v_mfma_f32_16x16x32_bf16 v[52:55], v[200:203], v[108:111], v[52:55]
    ds_read_b64_tr_b16 v[182:183], v233 offset:36864
    v_exp_f32 v243, v75
    v_mfma_f32_16x16x32_bf16 v[56:59], v[204:207], v[104:107], v[56:59]
    ds_read_b64_tr_b16 v[184:185], v234 offset:32768
    v_mfma_f32_16x16x32_bf16 v[60:63], v[204:207], v[108:111], v[60:63]
    v_cvt_pk_bf16_f32 v98, v246, v247
    v_or3_b32 v248, v96, v97, v98
    v_mfma_f32_16x16x32_bf16 v[216:219], v[224:227], v[104:107], v[216:219]
    v_exp_f32 v244, v68
    ds_read_b64_tr_b16 v[186:187], v234 offset:36864
    v_mfma_f32_16x16x32_bf16 v[220:223], v[224:227], v[108:111], v[220:223]
    v_exp_f32 v245, v69
    ds_read_b64_tr_b16 v[188:189], v235 offset:32768
    s_waitcnt lgkmcnt(7)
    v_mfma_f32_16x16x32_bf16 v[80:83], v[144:147], v[112:115], v[208:211]
    v_cvt_pk_bf16_f32 v99, v242, v243
    ds_read_b64_tr_b16 v[190:191], v235 offset:36864
    v_mfma_f32_16x16x32_bf16 v[80:83], v[148:151], v[116:119], v[80:83]
    v_exp_f32 v246, v70
    ds_read_b64_tr_b16 v[192:193], v236 offset:32768
    s_setprio 2
    v_mfma_f32_16x16x32_bf16 v[80:83], v[152:155], v[120:123], v[80:83]
    v_exp_f32 v247, v71
    v_mfma_f32_16x16x32_bf16 v[80:83], v[156:159], v[124:127], v[80:83]
    ds_read_b64_tr_b16 v[194:195], v236 offset:36864
    v_cvt_pk_bf16_f32 v100, v244, v245
    v_or3_b32 v248, v248, v99, v100
    v_mfma_f32_16x16x32_bf16 v[84:87], v[144:147], v[128:131], v[212:215]
    v_exp_f32 v242, v76
    ds_read_b64_tr_b16 v[196:197], v237 offset:32768
    v_mfma_f32_16x16x32_bf16 v[84:87], v[148:151], v[132:135], v[84:87]
    v_exp_f32 v243, v77
    ds_read_b64_tr_b16 v[198:199], v237 offset:36864
    v_mfma_f32_16x16x32_bf16 v[84:87], v[152:155], v[136:139], v[84:87]
    v_cvt_pk_bf16_f32 v101, v246, v247
    ds_read_b64_tr_b16 v[200:201], v238 offset:32768
    v_mfma_f32_16x16x32_bf16 v[84:87], v[156:159], v[140:143], v[84:87]
    v_exp_f32 v244, v78
    v_mfma_f32_16x16x32_bf16 v[88:91], v[160:163], v[112:115], v[208:211]
    ds_read_b64_tr_b16 v[202:203], v238 offset:36864
    v_exp_f32 v245, v79
    v_mfma_f32_16x16x32_bf16 v[88:91], v[164:167], v[116:119], v[88:91]
    v_cvt_pk_bf16_f32 v102, v242, v243
    ds_read_b64_tr_b16 v[204:205], v239 offset:32768
    v_mfma_f32_16x16x32_bf16 v[88:91], v[168:171], v[120:123], v[88:91]
    v_or3_b32 v248, v248, v101, v102
    v_cvt_pk_bf16_f32 v103, v244, v245
    ds_read_b64_tr_b16 v[206:207], v239 offset:36864
    v_mfma_f32_16x16x32_bf16 v[88:91], v[172:175], v[124:127], v[88:91]
    v_or_b32 v248, v248, v103
    v_and_b32 v248, 0x40004000, v248
    v_mfma_f32_16x16x32_bf16 v[92:95], v[160:163], v[128:131], v[212:215]
    v_cmp_ne_u32 vcc, 0, v248
    v_mfma_f32_16x16x32_bf16 v[92:95], v[164:167], v[132:135], v[92:95]
    v_mfma_f32_16x16x32_bf16 v[92:95], v[168:171], v[136:139], v[92:95]
    v_mfma_f32_16x16x32_bf16 v[92:95], v[172:175], v[140:143], v[92:95]
    s_cbranch_vccnz TR_20
BK_20:
STEP_21:
    s_waitcnt lgkmcnt(0)
    s_setprio 1
    v_mfma_f32_16x16x32_bf16 v[0:3], v[176:179], v[96:99], v[0:3]
    ds_read_b128 v[144:147], v228 offset:57344
    s_cmp_eq_u32 s0, 0
    s_cbranch_scc0 BU21V
    s_add_u32 m0, s72, 65536
    s_add_u32 s26, s72, 196608
    buffer_load_dwordx4 v241, s[36:39], s26 offen offset:0 nt lds
    v_xor_b32 v251, 128, v241
    buffer_load_dwordx4 v251, s[36:39], s26 offen offset:1024 nt lds
    buffer_load_dwordx4 v241, s[36:39], s26 offen offset:2048 nt lds
    v_xor_b32 v251, 128, v241
    buffer_load_dwordx4 v251, s[36:39], s26 offen offset:3072 nt lds
BU21V:
    v_mfma_f32_16x16x32_bf16 v[4:7], v[176:179], v[100:103], v[4:7]
    ds_read_b128 v[148:151], v229 offset:57344
    v_mfma_f32_16x16x32_bf16 v[8:11], v[180:183], v[96:99], v[8:11]
    ds_read_b128 v[152:155], v230 offset:57344
    v_mfma_f32_16x16x32_bf16 v[12:15], v[180:183], v[100:103], v[12:15]
    v_exp_f32 v242, v80
    v_mfma_f32_16x16x32_bf16 v[16:19], v[184:187], v[96:99], v[16:19]
    ds_read_b128 v[156:159], v231 offset:57344
    ds_read_b128 v[160:163], v228 offset:61440
    v_mfma_f32_16x16x32_bf16 v[20:23], v[184:187], v[100:103], v[20:23]
    v_exp_f32 v243, v81
    v_mfma_f32_16x16x32_bf16 v[24:27], v[188:191], v[96:99], v[24:27]
    v_exp_f32 v244, v82
    v_mfma_f32_16x16x32_bf16 v[28:31], v[188:191], v[100:103], v[28:31]
    ds_read_b128 v[164:167], v229 offset:61440
    ds_read_b128 v[168:171], v230 offset:61440
    v_mfma_f32_16x16x32_bf16 v[32:35], v[192:195], v[96:99], v[32:35]
    v_exp_f32 v245, v83
    v_mfma_f32_16x16x32_bf16 v[36:39], v[192:195], v[100:103], v[36:39]
    v_cvt_pk_bf16_f32 v104, v242, v243
    ds_read_b128 v[172:175], v231 offset:61440
    ds_read_b64_tr_b16 v[176:177], v232 offset:40960
    v_mfma_f32_16x16x32_bf16 v[40:43], v[196:199], v[96:99], v[40:43]
    v_exp_f32 v246, v88
    v_mfma_f32_16x16x32_bf16 v[44:47], v[196:199], v[100:103], v[44:47]
    v_exp_f32 v247, v89
    ds_read_b64_tr_b16 v[178:179], v232 offset:45056
    v_mfma_f32_16x16x32_bf16 v[48:51], v[200:203], v[96:99], v[48:51]
    v_cvt_pk_bf16_f32 v105, v244, v245
    ds_read_b64_tr_b16 v[180:181], v233 offset:40960
    v_exp_f32 v242, v90
    v_mfma_f32_16x16x32_bf16 v[52:55], v[200:203], v[100:103], v[52:55]
    ds_read_b64_tr_b16 v[182:183], v233 offset:45056
    v_exp_f32 v243, v91
    v_mfma_f32_16x16x32_bf16 v[56:59], v[204:207], v[96:99], v[56:59]
    ds_read_b64_tr_b16 v[184:185], v234 offset:40960
    v_mfma_f32_16x16x32_bf16 v[60:63], v[204:207], v[100:103], v[60:63]
    v_cvt_pk_bf16_f32 v106, v246, v247
    v_or3_b32 v248, v104, v105, v106
    v_mfma_f32_16x16x32_bf16 v[216:219], v[224:227], v[96:99], v[216:219]
    v_exp_f32 v244, v84
    ds_read_b64_tr_b16 v[186:187], v234 offset:45056
    v_mfma_f32_16x16x32_bf16 v[220:223], v[224:227], v[100:103], v[220:223]
    v_exp_f32 v245, v85
    ds_read_b64_tr_b16 v[188:189], v235 offset:40960
    s_waitcnt lgkmcnt(7)
    v_mfma_f32_16x16x32_bf16 v[64:67], v[144:147], v[112:115], v[208:211]
    v_cvt_pk_bf16_f32 v107, v242, v243
    ds_read_b64_tr_b16 v[190:191], v235 offset:45056
    v_mfma_f32_16x16x32_bf16 v[64:67], v[148:151], v[116:119], v[64:67]
    v_exp_f32 v246, v86
    ds_read_b64_tr_b16 v[192:193], v236 offset:40960
    s_setprio 0
    v_mfma_f32_16x16x32_bf16 v[64:67], v[152:155], v[120:123], v[64:67]
    v_exp_f32 v247, v87
    v_mfma_f32_16x16x32_bf16 v[64:67], v[156:159], v[124:127], v[64:67]
    ds_read_b64_tr_b16 v[194:195], v236 offset:45056
    v_cvt_pk_bf16_f32 v108, v244, v245
    v_or3_b32 v248, v248, v107, v108
    v_mfma_f32_16x16x32_bf16 v[68:71], v[144:147], v[128:131], v[212:215]
    v_exp_f32 v242, v92
    ds_read_b64_tr_b16 v[196:197], v237 offset:40960
    v_mfma_f32_16x16x32_bf16 v[68:71], v[148:151], v[132:135], v[68:71]
    v_exp_f32 v243, v93
    ds_read_b64_tr_b16 v[198:199], v237 offset:45056
    v_mfma_f32_16x16x32_bf16 v[68:71], v[152:155], v[136:139], v[68:71]
    v_cvt_pk_bf16_f32 v109, v246, v247
    ds_read_b64_tr_b16 v[200:201], v238 offset:40960
    v_mfma_f32_16x16x32_bf16 v[68:71], v[156:159], v[140:143], v[68:71]
    v_exp_f32 v244, v94
    v_mfma_f32_16x16x32_bf16 v[72:75], v[160:163], v[112:115], v[208:211]
    ds_read_b64_tr_b16 v[202:203], v238 offset:45056
    v_exp_f32 v245, v95
    v_mfma_f32_16x16x32_bf16 v[72:75], v[164:167], v[116:119], v[72:75]
    v_cvt_pk_bf16_f32 v110, v242, v243
    ds_read_b64_tr_b16 v[204:205], v239 offset:40960
    v_mfma_f32_16x16x32_bf16 v[72:75], v[168:171], v[120:123], v[72:75]
    v_or3_b32 v248, v248, v109, v110
    v_cvt_pk_bf16_f32 v111, v244, v245
    ds_read_b64_tr_b16 v[206:207], v239 offset:45056
    v_mfma_f32_16x16x32_bf16 v[72:75], v[172:175], v[124:127], v[72:75]
    v_or_b32 v248, v248, v111
    v_and_b32 v248, 0x40004000, v248
    v_mfma_f32_16x16x32_bf16 v[76:79], v[160:163], v[128:131], v[212:215]
    v_cmp_ne_u32 vcc, 0, v248
    v_mfma_f32_16x16x32_bf16 v[76:79], v[164:167], v[132:135], v[76:79]
    v_mfma_f32_16x16x32_bf16 v[76:79], v[168:171], v[136:139], v[76:79]
    v_mfma_f32_16x16x32_bf16 v[76:79], v[172:175], v[140:143], v[76:79]
    s_cbranch_vccnz TR_21
BK_21:
STEP_22:
    s_waitcnt vmcnt(4) lgkmcnt(0)
    s_barrier
    s_setprio 3
    v_mfma_f32_16x16x32_bf16 v[0:3], v[176:179], v[104:107], v[0:3]
    ds_read_b128 v[144:147], v228 offset:0
    s_cmp_eq_u32 s0, 0
    s_cbranch_scc0 BU22K
    s_add_u32 m0, s72, 16384
    s_add_u32 s26, s72, 204800
    buffer_load_dwordx4 v240, s[32:35], s26 offen offset:0 nt lds
    v_xor_b32 v251, 64, v240
    buffer_load_dwordx4 v251, s[32:35], s26 offen offset:1024 nt lds
    v_xor_b32 v250, 128, v240
    buffer_load_dwordx4 v250, s[32:35], s26 offen offset:2048 nt lds
    v_xor_b32 v251, 192, v240
    buffer_load_dwordx4 v251, s[32:35], s26 offen offset:3072 nt lds
BU22K:
    v_mfma_f32_16x16x32_bf16 v[4:7], v[176:179], v[108:111], v[4:7]
    ds_read_b128 v[148:151], v229 offset:0
    v_mfma_f32_16x16x32_bf16 v[8:11], v[180:183], v[104:107], v[8:11]
    ds_read_b128 v[152:155], v230 offset:0
    v_mfma_f32_16x16x32_bf16 v[12:15], v[180:183], v[108:111], v[12:15]
    v_exp_f32 v242, v64
    v_mfma_f32_16x16x32_bf16 v[16:19], v[184:187], v[104:107], v[16:19]
    ds_read_b128 v[156:159], v231 offset:0
    ds_read_b128 v[160:163], v228 offset:4096
    v_mfma_f32_16x16x32_bf16 v[20:23], v[184:187], v[108:111], v[20:23]
    v_exp_f32 v243, v65
    v_mfma_f32_16x16x32_bf16 v[24:27], v[188:191], v[104:107], v[24:27]
    v_exp_f32 v244, v66
    v_mfma_f32_16x16x32_bf16 v[28:31], v[188:191], v[108:111], v[28:31]
    ds_read_b128 v[164:167], v229 offset:4096
    ds_read_b128 v[168:171], v230 offset:4096
    v_mfma_f32_16x16x32_bf16 v[32:35], v[192:195], v[104:107], v[32:35]
    v_exp_f32 v245, v67
    v_mfma_f32_16x16x32_bf16 v[36:39], v[192:195], v[108:111], v[36:39]
    v_cvt_pk_bf16_f32 v96, v242, v243
    ds_read_b128 v[172:175], v231 offset:4096
    ds_read_b64_tr_b16 v[176:177], v232 offset:49152
    v_mfma_f32_16x16x32_bf16 v[40:43], v[196:199], v[104:107], v[40:43]
    v_exp_f32 v246, v72
    v_mfma_f32_16x16x32_bf16 v[44:47], v[196:199], v[108:111], v[44:47]
    v_exp_f32 v247, v73
    ds_read_b64_tr_b16 v[178:179], v232 offset:53248
    v_mfma_f32_16x16x32_bf16 v[48:51], v[200:203], v[104:107], v[48:51]
    v_cvt_pk_bf16_f32 v97, v244, v245
    ds_read_b64_tr_b16 v[180:181], v233 offset:49152
    v_exp_f32 v242, v74
    v_mfma_f32_16x16x32_bf16 v[52:55], v[200:203], v[108:111], v[52:55]
    ds_read_b64_tr_b16 v[182:183], v233 offset:53248
    v_exp_f32 v243, v75
    v_mfma_f32_16x16x32_bf16 v[56:59], v[204:207], v[104:107], v[56:59]
    ds_read_b64_tr_b16 v[184:185], v234 offset:49152
    v_mfma_f32_16x16x32_bf16 v[60:63], v[204:207], v[108:111], v[60:63]
    v_cvt_pk_bf16_f32 v98, v246, v247
    v_or3_b32 v248, v96, v97, v98
    v_mfma_f32_16x16x32_bf16 v[216:219], v[224:227], v[104:107], v[216:219]
    v_exp_f32 v244, v68
    ds_read_b64_tr_b16 v[186:187], v234 offset:53248
    v_mfma_f32_16x16x32_bf16 v[220:223], v[224:227], v[108:111], v[220:223]
    v_exp_f32 v245, v69
    ds_read_b64_tr_b16 v[188:189], v235 offset:49152
    s_waitcnt lgkmcnt(7)
    v_mfma_f32_16x16x32_bf16 v[80:83], v[144:147], v[112:115], v[208:211]
    v_cvt_pk_bf16_f32 v99, v242, v243
    ds_read_b64_tr_b16 v[190:191], v235 offset:53248
    v_mfma_f32_16x16x32_bf16 v[80:83], v[148:151], v[116:119], v[80:83]
    v_exp_f32 v246, v70
    ds_read_b64_tr_b16 v[192:193], v236 offset:49152
    s_setprio 2
    v_mfma_f32_16x16x32_bf16 v[80:83], v[152:155], v[120:123], v[80:83]
    v_exp_f32 v247, v71
    v_mfma_f32_16x16x32_bf16 v[80:83], v[156:159], v[124:127], v[80:83]
    ds_read_b64_tr_b16 v[194:195], v236 offset:53248
    v_cvt_pk_bf16_f32 v100, v244, v245
    v_or3_b32 v248, v248, v99, v100
    v_mfma_f32_16x16x32_bf16 v[84:87], v[144:147], v[128:131], v[212:215]
    v_exp_f32 v242, v76
    ds_read_b64_tr_b16 v[196:197], v237 offset:49152
    v_mfma_f32_16x16x32_bf16 v[84:87], v[148:151], v[132:135], v[84:87]
    v_exp_f32 v243, v77
    ds_read_b64_tr_b16 v[198:199], v237 offset:53248
    v_mfma_f32_16x16x32_bf16 v[84:87], v[152:155], v[136:139], v[84:87]
    v_cvt_pk_bf16_f32 v101, v246, v247
    ds_read_b64_tr_b16 v[200:201], v238 offset:49152
    v_mfma_f32_16x16x32_bf16 v[84:87], v[156:159], v[140:143], v[84:87]
    v_exp_f32 v244, v78
    v_mfma_f32_16x16x32_bf16 v[88:91], v[160:163], v[112:115], v[208:211]
    ds_read_b64_tr_b16 v[202:203], v238 offset:53248
    v_exp_f32 v245, v79
    v_mfma_f32_16x16x32_bf16 v[88:91], v[164:167], v[116:119], v[88:91]
    v_cvt_pk_bf16_f32 v102, v242, v243
    ds_read_b64_tr_b16 v[204:205], v239 offset:49152
    v_mfma_f32_16x16x32_bf16 v[88:91], v[168:171], v[120:123], v[88:91]
    v_or3_b32 v248, v248, v101, v102
    v_cvt_pk_bf16_f32 v103, v244, v245
    ds_read_b64_tr_b16 v[206:207], v239 offset:53248
    v_mfma_f32_16x16x32_bf16 v[88:91], v[172:175], v[124:127], v[88:91]
    v_or_b32 v248, v248, v103
    v_and_b32 v248, 0x40004000, v248
    v_mfma_f32_16x16x32_bf16 v[92:95], v[160:163], v[128:131], v[212:215]
    v_cmp_ne_u32 vcc, 0, v248
    v_mfma_f32_16x16x32_bf16 v[92:95], v[164:167], v[132:135], v[92:95]
    v_mfma_f32_16x16x32_bf16 v[92:95], v[168:171], v[136:139], v[92:95]
    v_mfma_f32_16x16x32_bf16 v[92:95], v[172:175], v[140:143], v[92:95]
    s_cbranch_vccnz TR_22
BK_22:
STEP_23:
    s_waitcnt lgkmcnt(0)
    s_setprio 1
    v_mfma_f32_16x16x32_bf16 v[0:3], v[176:179], v[96:99], v[0:3]
    ds_read_b128 v[144:147], v228 offset:8192
    s_cmp_eq_u32 s0, 0
    s_cbranch_scc0 BU23V
    s_add_u32 m0, s72, 81920
    s_add_u32 s26, s72, 212992
    buffer_load_dwordx4 v241, s[36:39], s26 offen offset:0 nt lds
    v_xor_b32 v251, 128, v241
    buffer_load_dwordx4 v251, s[36:39], s26 offen offset:1024 nt lds
    buffer_load_dwordx4 v241, s[36:39], s26 offen offset:2048 nt lds
    v_xor_b32 v251, 128, v241
    buffer_load_dwordx4 v251, s[36:39], s26 offen offset:3072 nt lds
BU23V:
    v_mfma_f32_16x16x32_bf16 v[4:7], v[176:179], v[100:103], v[4:7]
    ds_read_b128 v[148:151], v229 offset:8192
    v_mfma_f32_16x16x32_bf16 v[8:11], v[180:183], v[96:99], v[8:11]
    ds_read_b128 v[152:155], v230 offset:8192
    v_mfma_f32_16x16x32_bf16 v[12:15], v[180:183], v[100:103], v[12:15]
    v_exp_f32 v242, v80
    v_mfma_f32_16x16x32_bf16 v[16:19], v[184:187], v[96:99], v[16:19]
    ds_read_b128 v[156:159], v231 offset:8192
    ds_read_b128 v[160:163], v228 offset:12288
    v_mfma_f32_16x16x32_bf16 v[20:23], v[184:187], v[100:103], v[20:23]
    v_exp_f32 v243, v81
    v_mfma_f32_16x16x32_bf16 v[24:27], v[188:191], v[96:99], v[24:27]
    v_exp_f32 v244, v82
    v_mfma_f32_16x16x32_bf16 v[28:31], v[188:191], v[100:103], v[28:31]
    ds_read_b128 v[164:167], v229 offset:12288
    ds_read_b128 v[168:171], v230 offset:12288
    v_mfma_f32_16x16x32_bf16 v[32:35], v[192:195], v[96:99], v[32:35]
    v_exp_f32 v245, v83
    v_mfma_f32_16x16x32_bf16 v[36:39], v[192:195], v[100:103], v[36:39]
    v_cvt_pk_bf16_f32 v104, v242, v243
    ds_read_b128 v[172:175], v231 offset:12288
    ds_read_b64_tr_b16 v[176:177], v232 offset:57344
    v_mfma_f32_16x16x32_bf16 v[40:43], v[196:199], v[96:99], v[40:43]
    v_exp_f32 v246, v88
    v_mfma_f32_16x16x32_bf16 v[44:47], v[196:199], v[100:103], v[44:47]
    v_exp_f32 v247, v89
    ds_read_b64_tr_b16 v[178:179], v232 offset:61440
    v_mfma_f32_16x16x32_bf16 v[48:51], v[200:203], v[96:99], v[48:51]
    v_cvt_pk_bf16_f32 v105, v244, v245
    ds_read_b64_tr_b16 v[180:181], v233 offset:57344
    v_exp_f32 v242, v90
    v_mfma_f32_16x16x32_bf16 v[52:55], v[200:203], v[100:103], v[52:55]
    ds_read_b64_tr_b16 v[182:183], v233 offset:61440
    v_exp_f32 v243, v91
    v_mfma_f32_16x16x32_bf16 v[56:59], v[204:207], v[96:99], v[56:59]
    ds_read_b64_tr_b16 v[184:185], v234 offset:57344
    v_mfma_f32_16x16x32_bf16 v[60:63], v[204:207], v[100:103], v[60:63]
    v_cvt_pk_bf16_f32 v106, v246, v247
    v_or3_b32 v248, v104, v105, v106
    v_mfma_f32_16x16x32_bf16 v[216:219], v[224:227], v[96:99], v[216:219]
    v_exp_f32 v244, v84
    ds_read_b64_tr_b16 v[186:187], v234 offset:61440
    v_mfma_f32_16x16x32_bf16 v[220:223], v[224:227], v[100:103], v[220:223]
    v_exp_f32 v245, v85
    ds_read_b64_tr_b16 v[188:189], v235 offset:57344
    s_waitcnt lgkmcnt(7)
    v_mfma_f32_16x16x32_bf16 v[64:67], v[144:147], v[112:115], v[208:211]
    v_cvt_pk_bf16_f32 v107, v242, v243
    ds_read_b64_tr_b16 v[190:191], v235 offset:61440
    v_mfma_f32_16x16x32_bf16 v[64:67], v[148:151], v[116:119], v[64:67]
    v_exp_f32 v246, v86
    ds_read_b64_tr_b16 v[192:193], v236 offset:57344
    s_setprio 0
    v_mfma_f32_16x16x32_bf16 v[64:67], v[152:155], v[120:123], v[64:67]
    v_exp_f32 v247, v87
    v_mfma_f32_16x16x32_bf16 v[64:67], v[156:159], v[124:127], v[64:67]
    ds_read_b64_tr_b16 v[194:195], v236 offset:61440
    v_cvt_pk_bf16_f32 v108, v244, v245
    v_or3_b32 v248, v248, v107, v108
    v_mfma_f32_16x16x32_bf16 v[68:71], v[144:147], v[128:131], v[212:215]
    v_exp_f32 v242, v92
    ds_read_b64_tr_b16 v[196:197], v237 offset:57344
    v_mfma_f32_16x16x32_bf16 v[68:71], v[148:151], v[132:135], v[68:71]
    v_exp_f32 v243, v93
    ds_read_b64_tr_b16 v[198:199], v237 offset:61440
    v_mfma_f32_16x16x32_bf16 v[68:71], v[152:155], v[136:139], v[68:71]
    v_cvt_pk_bf16_f32 v109, v246, v247
    ds_read_b64_tr_b16 v[200:201], v238 offset:57344
    v_mfma_f32_16x16x32_bf16 v[68:71], v[156:159], v[140:143], v[68:71]
    v_exp_f32 v244, v94
    v_mfma_f32_16x16x32_bf16 v[72:75], v[160:163], v[112:115], v[208:211]
    ds_read_b64_tr_b16 v[202:203], v238 offset:61440
    v_exp_f32 v245, v95
    v_mfma_f32_16x16x32_bf16 v[72:75], v[164:167], v[116:119], v[72:75]
    v_cvt_pk_bf16_f32 v110, v242, v243
    ds_read_b64_tr_b16 v[204:205], v239 offset:57344
    v_mfma_f32_16x16x32_bf16 v[72:75], v[168:171], v[120:123], v[72:75]
    v_or3_b32 v248, v248, v109, v110
    v_cvt_pk_bf16_f32 v111, v244, v245
    ds_read_b64_tr_b16 v[206:207], v239 offset:61440
    v_mfma_f32_16x16x32_bf16 v[72:75], v[172:175], v[124:127], v[72:75]
    v_or_b32 v248, v248, v111
    v_and_b32 v248, 0x40004000, v248
    v_mfma_f32_16x16x32_bf16 v[76:79], v[160:163], v[128:131], v[212:215]
    v_cmp_ne_u32 vcc, 0, v248
    v_mfma_f32_16x16x32_bf16 v[76:79], v[164:167], v[132:135], v[76:79]
    v_mfma_f32_16x16x32_bf16 v[76:79], v[168:171], v[136:139], v[76:79]
    v_mfma_f32_16x16x32_bf16 v[76:79], v[172:175], v[140:143], v[76:79]
    s_cbranch_vccnz TR_23
BK_23:
STEP_24:
    s_waitcnt vmcnt(4) lgkmcnt(0)
    s_barrier
    s_setprio 3
    v_mfma_f32_16x16x32_bf16 v[0:3], v[176:179], v[104:107], v[0:3]
    ds_read_b128 v[144:147], v228 offset:16384
    s_cmp_eq_u32 s0, 0
    s_cbranch_scc0 BU24K
    s_add_u32 m0, s72, 32768
    s_add_u32 s26, s72, 221184
    buffer_load_dwordx4 v240, s[32:35], s26 offen offset:0 nt lds
    v_xor_b32 v251, 64, v240
    buffer_load_dwordx4 v251, s[32:35], s26 offen offset:1024 nt lds
    v_xor_b32 v250, 128, v240
    buffer_load_dwordx4 v250, s[32:35], s26 offen offset:2048 nt lds
    v_xor_b32 v251, 192, v240
    buffer_load_dwordx4 v251, s[32:35], s26 offen offset:3072 nt lds
BU24K:
    v_mfma_f32_16x16x32_bf16 v[4:7], v[176:179], v[108:111], v[4:7]
    ds_read_b128 v[148:151], v229 offset:16384
    v_mfma_f32_16x16x32_bf16 v[8:11], v[180:183], v[104:107], v[8:11]
    ds_read_b128 v[152:155], v230 offset:16384
    v_mfma_f32_16x16x32_bf16 v[12:15], v[180:183], v[108:111], v[12:15]
    v_exp_f32 v242, v64
    v_mfma_f32_16x16x32_bf16 v[16:19], v[184:187], v[104:107], v[16:19]
    ds_read_b128 v[156:159], v231 offset:16384
    ds_read_b128 v[160:163], v228 offset:20480
    v_mfma_f32_16x16x32_bf16 v[20:23], v[184:187], v[108:111], v[20:23]
    v_exp_f32 v243, v65
    v_mfma_f32_16x16x32_bf16 v[24:27], v[188:191], v[104:107], v[24:27]
    v_exp_f32 v244, v66
    v_mfma_f32_16x16x32_bf16 v[28:31], v[188:191], v[108:111], v[28:31]
    ds_read_b128 v[164:167], v229 offset:20480
    ds_read_b128 v[168:171], v230 offset:20480
    v_mfma_f32_16x16x32_bf16 v[32:35], v[192:195], v[104:107], v[32:35]
    v_exp_f32 v245, v67
    v_mfma_f32_16x16x32_bf16 v[36:39], v[192:195], v[108:111], v[36:39]
    v_cvt_pk_bf16_f32 v96, v242, v243
    ds_read_b128 v[172:175], v231 offset:20480
    ds_read_b64_tr_b16 v[176:177], v232 offset:0
    v_mfma_f32_16x16x32_bf16 v[40:43], v[196:199], v[104:107], v[40:43]
    v_exp_f32 v246, v72
    v_mfma_f32_16x16x32_bf16 v[44:47], v[196:199], v[108:111], v[44:47]
    v_exp_f32 v247, v73
    ds_read_b64_tr_b16 v[178:179], v232 offset:4096
    v_mfma_f32_16x16x32_bf16 v[48:51], v[200:203], v[104:107], v[48:51]
    v_cvt_pk_bf16_f32 v97, v244, v245
    ds_read_b64_tr_b16 v[180:181], v233 offset:0
    v_exp_f32 v242, v74
    v_mfma_f32_16x16x32_bf16 v[52:55], v[200:203], v[108:111], v[52:55]
    ds_read_b64_tr_b16 v[182:183], v233 offset:4096
    v_exp_f32 v243, v75
    v_mfma_f32_16x16x32_bf16 v[56:59], v[204:207], v[104:107], v[56:59]
    ds_read_b64_tr_b16 v[184:185], v234 offset:0
    v_mfma_f32_16x16x32_bf16 v[60:63], v[204:207], v[108:111], v[60:63]
    v_cvt_pk_bf16_f32 v98, v246, v247
    v_or3_b32 v248, v96, v97, v98
    v_mfma_f32_16x16x32_bf16 v[216:219], v[224:227], v[104:107], v[216:219]
    v_exp_f32 v244, v68
    ds_read_b64_tr_b16 v[186:187], v234 offset:4096
    v_mfma_f32_16x16x32_bf16 v[220:223], v[224:227], v[108:111], v[220:223]
    v_exp_f32 v245, v69
    ds_read_b64_tr_b16 v[188:189], v235 offset:0
    s_waitcnt lgkmcnt(7)
    v_mfma_f32_16x16x32_bf16 v[80:83], v[144:147], v[112:115], v[208:211]
    v_cvt_pk_bf16_f32 v99, v242, v243
    ds_read_b64_tr_b16 v[190:191], v235 offset:4096
    v_mfma_f32_16x16x32_bf16 v[80:83], v[148:151], v[116:119], v[80:83]
    v_exp_f32 v246, v70
    ds_read_b64_tr_b16 v[192:193], v236 offset:0
    s_setprio 2
    v_mfma_f32_16x16x32_bf16 v[80:83], v[152:155], v[120:123], v[80:83]
    v_exp_f32 v247, v71
    v_mfma_f32_16x16x32_bf16 v[80:83], v[156:159], v[124:127], v[80:83]
    ds_read_b64_tr_b16 v[194:195], v236 offset:4096
    v_cvt_pk_bf16_f32 v100, v244, v245
    v_or3_b32 v248, v248, v99, v100
    v_mfma_f32_16x16x32_bf16 v[84:87], v[144:147], v[128:131], v[212:215]
    v_exp_f32 v242, v76
    ds_read_b64_tr_b16 v[196:197], v237 offset:0
    v_mfma_f32_16x16x32_bf16 v[84:87], v[148:151], v[132:135], v[84:87]
    v_exp_f32 v243, v77
    ds_read_b64_tr_b16 v[198:199], v237 offset:4096
    v_mfma_f32_16x16x32_bf16 v[84:87], v[152:155], v[136:139], v[84:87]
    v_cvt_pk_bf16_f32 v101, v246, v247
    ds_read_b64_tr_b16 v[200:201], v238 offset:0
    v_mfma_f32_16x16x32_bf16 v[84:87], v[156:159], v[140:143], v[84:87]
    v_exp_f32 v244, v78
    v_mfma_f32_16x16x32_bf16 v[88:91], v[160:163], v[112:115], v[208:211]
    ds_read_b64_tr_b16 v[202:203], v238 offset:4096
    v_exp_f32 v245, v79
    v_mfma_f32_16x16x32_bf16 v[88:91], v[164:167], v[116:119], v[88:91]
    v_cvt_pk_bf16_f32 v102, v242, v243
    ds_read_b64_tr_b16 v[204:205], v239 offset:0
    v_mfma_f32_16x16x32_bf16 v[88:91], v[168:171], v[120:123], v[88:91]
    v_or3_b32 v248, v248, v101, v102
    v_cvt_pk_bf16_f32 v103, v244, v245
    ds_read_b64_tr_b16 v[206:207], v239 offset:4096
    v_mfma_f32_16x16x32_bf16 v[88:91], v[172:175], v[124:127], v[88:91]
    v_or_b32 v248, v248, v103
    v_and_b32 v248, 0x40004000, v248
    v_mfma_f32_16x16x32_bf16 v[92:95], v[160:163], v[128:131], v[212:215]
    v_cmp_ne_u32 vcc, 0, v248
    v_mfma_f32_16x16x32_bf16 v[92:95], v[164:167], v[132:135], v[92:95]
    v_mfma_f32_16x16x32_bf16 v[92:95], v[168:171], v[136:139], v[92:95]
    v_mfma_f32_16x16x32_bf16 v[92:95], v[172:175], v[140:143], v[92:95]
    s_cbranch_vccnz TR_24
BK_24:
STEP_25:
    s_waitcnt lgkmcnt(0)
    s_setprio 1
    v_mfma_f32_16x16x32_bf16 v[0:3], v[176:179], v[96:99], v[0:3]
    ds_read_b128 v[144:147], v228 offset:24576
    s_cmp_eq_u32 s0, 0
    s_cbranch_scc0 BU25V
    s_add_u32 m0, s72, 98304
    s_add_u32 s26, s72, 229376
    buffer_load_dwordx4 v241, s[36:39], s26 offen offset:0 nt lds
    v_xor_b32 v251, 128, v241
    buffer_load_dwordx4 v251, s[36:39], s26 offen offset:1024 nt lds
    buffer_load_dwordx4 v241, s[36:39], s26 offen offset:2048 nt lds
    v_xor_b32 v251, 128, v241
    buffer_load_dwordx4 v251, s[36:39], s26 offen offset:3072 nt lds
BU25V:
    v_mfma_f32_16x16x32_bf16 v[4:7], v[176:179], v[100:103], v[4:7]
    ds_read_b128 v[148:151], v229 offset:24576
    v_mfma_f32_16x16x32_bf16 v[8:11], v[180:183], v[96:99], v[8:11]
    ds_read_b128 v[152:155], v230 offset:24576
    v_mfma_f32_16x16x32_bf16 v[12:15], v[180:183], v[100:103], v[12:15]
    v_exp_f32 v242, v80
    v_mfma_f32_16x16x32_bf16 v[16:19], v[184:187], v[96:99], v[16:19]
    ds_read_b128 v[156:159], v231 offset:24576
    ds_read_b128 v[160:163], v228 offset:28672
    v_mfma_f32_16x16x32_bf16 v[20:23], v[184:187], v[100:103], v[20:23]
    v_exp_f32 v243, v81
    v_mfma_f32_16x16x32_bf16 v[24:27], v[188:191], v[96:99], v[24:27]
    v_exp_f32 v244, v82
    v_mfma_f32_16x16x32_bf16 v[28:31], v[188:191], v[100:103], v[28:31]
    ds_read_b128 v[164:167], v229 offset:28672
    ds_read_b128 v[168:171], v230 offset:28672
    v_mfma_f32_16x16x32_bf16 v[32:35], v[192:195], v[96:99], v[32:35]
    v_exp_f32 v245, v83
    s_cmp_lg_u32 s24, s96
    s_cbranch_scc1 SY25
    s_waitcnt vmcnt(0)
    v_mov_b32 v251, 155648
    ds_write_b32 v251, v254
SY25:
    v_mfma_f32_16x16x32_bf16 v[36:39], v[192:195], v[100:103], v[36:39]
    v_cvt_pk_bf16_f32 v104, v242, v243
    ds_read_b128 v[172:175], v231 offset:28672
    ds_read_b64_tr_b16 v[176:177], v232 offset:8192
    v_mfma_f32_16x16x32_bf16 v[40:43], v[196:199], v[96:99], v[40:43]
    v_exp_f32 v246, v88
    v_mfma_f32_16x16x32_bf16 v[44:47], v[196:199], v[100:103], v[44:47]
    v_exp_f32 v247, v89
    ds_read_b64_tr_b16 v[178:179], v232 offset:12288
    v_mfma_f32_16x16x32_bf16 v[48:51], v[200:203], v[96:99], v[48:51]
    v_cvt_pk_bf16_f32 v105, v244, v245
    ds_read_b64_tr_b16 v[180:181], v233 offset:8192
    v_exp_f32 v242, v90
    v_mfma_f32_16x16x32_bf16 v[52:55], v[200:203], v[100:103], v[52:55]
    ds_read_b64_tr_b16 v[182:183], v233 offset:12288
    v_exp_f32 v243, v91
    v_mfma_f32_16x16x32_bf16 v[56:59], v[204:207], v[96:99], v[56:59]
    ds_read_b64_tr_b16 v[184:185], v234 offset:8192
    v_mfma_f32_16x16x32_bf16 v[60:63], v[204:207], v[100:103], v[60:63]
    v_cvt_pk_bf16_f32 v106, v246, v247
    v_or3_b32 v248, v104, v105, v106
    v_mfma_f32_16x16x32_bf16 v[216:219], v[224:227], v[96:99], v[216:219]
    v_exp_f32 v244, v84
    ds_read_b64_tr_b16 v[186:187], v234 offset:12288
    v_mfma_f32_16x16x32_bf16 v[220:223], v[224:227], v[100:103], v[220:223]
    v_exp_f32 v245, v85
    ds_read_b64_tr_b16 v[188:189], v235 offset:8192
    s_waitcnt lgkmcnt(7)
    v_mfma_f32_16x16x32_bf16 v[64:67], v[144:147], v[112:115], v[208:211]
    v_cvt_pk_bf16_f32 v107, v242, v243
    ds_read_b64_tr_b16 v[190:191], v235 offset:12288
    v_mfma_f32_16x16x32_bf16 v[64:67], v[148:151], v[116:119], v[64:67]
    v_exp_f32 v246, v86
    ds_read_b64_tr_b16 v[192:193], v236 offset:8192
    s_setprio 0
    v_mfma_f32_16x16x32_bf16 v[64:67], v[152:155], v[120:123], v[64:67]
    v_exp_f32 v247, v87
    v_mfma_f32_16x16x32_bf16 v[64:67], v[156:159], v[124:127], v[64:67]
    ds_read_b64_tr_b16 v[194:195], v236 offset:12288
    v_cvt_pk_bf16_f32 v108, v244, v245
    v_or3_b32 v248, v248, v107, v108
    v_mfma_f32_16x16x32_bf16 v[68:71], v[144:147], v[128:131], v[212:215]
    v_exp_f32 v242, v92
    ds_read_b64_tr_b16 v[196:197], v237 offset:8192
    v_mfma_f32_16x16x32_bf16 v[68:71], v[148:151], v[132:135], v[68:71]
    v_exp_f32 v243, v93
    ds_read_b64_tr_b16 v[198:199], v237 offset:12288
    v_mfma_f32_16x16x32_bf16 v[68:71], v[152:155], v[136:139], v[68:71]
    v_cvt_pk_bf16_f32 v109, v246, v247
    ds_read_b64_tr_b16 v[200:201], v238 offset:8192
    v_mfma_f32_16x16x32_bf16 v[68:71], v[156:159], v[140:143], v[68:71]
    v_exp_f32 v244, v94
    v_mfma_f32_16x16x32_bf16 v[72:75], v[160:163], v[112:115], v[208:211]
    ds_read_b64_tr_b16 v[202:203], v238 offset:12288
    v_exp_f32 v245, v95
    v_mfma_f32_16x16x32_bf16 v[72:75], v[164:167], v[116:119], v[72:75]
    v_cvt_pk_bf16_f32 v110, v242, v243
    ds_read_b64_tr_b16 v[204:205], v239 offset:8192
    v_mfma_f32_16x16x32_bf16 v[72:75], v[168:171], v[120:123], v[72:75]
    v_or3_b32 v248, v248, v109, v110
    v_cvt_pk_bf16_f32 v111, v244, v245
    ds_read_b64_tr_b16 v[206:207], v239 offset:12288
    v_mfma_f32_16x16x32_bf16 v[72:75], v[172:175], v[124:127], v[72:75]
    v_or_b32 v248, v248, v111
    v_and_b32 v248, 0x40004000, v248
    v_mfma_f32_16x16x32_bf16 v[76:79], v[160:163], v[128:131], v[212:215]
    v_cmp_ne_u32 vcc, 0, v248
    v_mfma_f32_16x16x32_bf16 v[76:79], v[164:167], v[132:135], v[76:79]
    v_mfma_f32_16x16x32_bf16 v[76:79], v[168:171], v[136:139], v[76:79]
    v_mfma_f32_16x16x32_bf16 v[76:79], v[172:175], v[140:143], v[76:79]
    s_cbranch_vccnz TR_25
BK_25:
STEP_26:
    s_waitcnt vmcnt(4) lgkmcnt(0)
    s_barrier
    s_setprio 3
    v_mfma_f32_16x16x32_bf16 v[0:3], v[176:179], v[104:107], v[0:3]
    ds_read_b128 v[144:147], v228 offset:32768
    s_cmp_eq_u32 s0, 0
    s_cbranch_scc0 BU26K
    s_add_u32 m0, s72, 49152
    s_add_u32 s26, s72, 237568
    buffer_load_dwordx4 v240, s[32:35], s26 offen offset:0 nt lds
    v_xor_b32 v251, 64, v240
    buffer_load_dwordx4 v251, s[32:35], s26 offen offset:1024 nt lds
    v_xor_b32 v250, 128, v240
    buffer_load_dwordx4 v250, s[32:35], s26 offen offset:2048 nt lds
    v_xor_b32 v251, 192, v240
    buffer_load_dwordx4 v251, s[32:35], s26 offen offset:3072 nt lds
BU26K:
    v_mfma_f32_16x16x32_bf16 v[4:7], v[176:179], v[108:111], v[4:7]
    ds_read_b128 v[148:151], v229 offset:32768
    v_mfma_f32_16x16x32_bf16 v[8:11], v[180:183], v[104:107], v[8:11]
    ds_read_b128 v[152:155], v230 offset:32768
    v_mfma_f32_16x16x32_bf16 v[12:15], v[180:183], v[108:111], v[12:15]
    v_exp_f32 v242, v64
    v_mfma_f32_16x16x32_bf16 v[16:19], v[184:187], v[104:107], v[16:19]
    ds_read_b128 v[156:159], v231 offset:32768
    ds_read_b128 v[160:163], v228 offset:36864
    v_mfma_f32_16x16x32_bf16 v[20:23], v[184:187], v[108:111], v[20:23]
    v_exp_f32 v243, v65
    v_mfma_f32_16x16x32_bf16 v[24:27], v[188:191], v[104:107], v[24:27]
    v_exp_f32 v244, v66
    v_mfma_f32_16x16x32_bf16 v[28:31], v[188:191], v[108:111], v[28:31]
    ds_read_b128 v[164:167], v229 offset:36864
    ds_read_b128 v[168:171], v230 offset:36864
    v_mfma_f32_16x16x32_bf16 v[32:35], v[192:195], v[104:107], v[32:35]
    v_exp_f32 v245, v67
    s_cmp_eq_u32 s0, 0
    s_cbranch_scc0 TDE
    s_cmp_lt_u32 s72, 8192
    s_cbranch_scc0 TDE
    s_add_u32 m0, s72, 131072
    s_nop 0
    buffer_load_dwordx4 v240, s[44:47], s72 offen offset:0 lds
    v_xor_b32 v251, 64, v240
    buffer_load_dwordx4 v251, s[44:47], s72 offen offset:1024 lds
    v_xor_b32 v250, 128, v240
    buffer_load_dwordx4 v250, s[44:47], s72 offen offset:2048 lds
    v_xor_b32 v251, 192, v240
    buffer_load_dwordx4 v251, s[44:47], s72 offen offset:3072 lds
    s_add_u32 m0, s72, 139264
    s_nop 0
    buffer_load_dwordx4 v241, s[48:51], s72 offen offset:0 lds
    v_xor_b32 v251, 128, v241
    buffer_load_dwordx4 v251, s[48:51], s72 offen offset:1024 lds
    buffer_load_dwordx4 v241, s[48:51], s72 offen offset:2048 lds
    v_xor_b32 v251, 128, v241
    buffer_load_dwordx4 v251, s[48:51], s72 offen offset:3072 lds
    s_add_u32 m0, s72, 147456
    v_lshlrev_b32 v250, 4, v249
    buffer_load_dwordx4 v250, s[52:55], s72 offen offset:0 lds
    buffer_load_dwordx4 v250, s[52:55], s72 offen offset:1024 lds
TDE:
    v_mfma_f32_16x16x32_bf16 v[36:39], v[192:195], v[108:111], v[36:39]
    v_cvt_pk_bf16_f32 v96, v242, v243
    ds_read_b128 v[172:175], v231 offset:36864
    ds_read_b64_tr_b16 v[176:177], v232 offset:16384
    v_mfma_f32_16x16x32_bf16 v[40:43], v[196:199], v[104:107], v[40:43]
    v_exp_f32 v246, v72
    v_mfma_f32_16x16x32_bf16 v[44:47], v[196:199], v[108:111], v[44:47]
    v_exp_f32 v247, v73
    ds_read_b64_tr_b16 v[178:179], v232 offset:20480
    v_mfma_f32_16x16x32_bf16 v[48:51], v[200:203], v[104:107], v[48:51]
    v_cvt_pk_bf16_f32 v97, v244, v245
    ds_read_b64_tr_b16 v[180:181], v233 offset:16384
    v_exp_f32 v242, v74
    v_mfma_f32_16x16x32_bf16 v[52:55], v[200:203], v[108:111], v[52:55]
    ds_read_b64_tr_b16 v[182:183], v233 offset:20480
    v_exp_f32 v243, v75
    v_mfma_f32_16x16x32_bf16 v[56:59], v[204:207], v[104:107], v[56:59]
    ds_read_b64_tr_b16 v[184:185], v234 offset:16384
    v_mfma_f32_16x16x32_bf16 v[60:63], v[204:207], v[108:111], v[60:63]
    v_cvt_pk_bf16_f32 v98, v246, v247
    v_or3_b32 v248, v96, v97, v98
    v_mfma_f32_16x16x32_bf16 v[216:219], v[224:227], v[104:107], v[216:219]
    v_exp_f32 v244, v68
    ds_read_b64_tr_b16 v[186:187], v234 offset:20480
    v_mfma_f32_16x16x32_bf16 v[220:223], v[224:227], v[108:111], v[220:223]
    v_exp_f32 v245, v69
    ds_read_b64_tr_b16 v[188:189], v235 offset:16384
    s_waitcnt lgkmcnt(7)
    v_mfma_f32_16x16x32_bf16 v[80:83], v[144:147], v[112:115], v[208:211]
    v_cvt_pk_bf16_f32 v99, v242, v243
    ds_read_b64_tr_b16 v[190:191], v235 offset:20480
    v_mfma_f32_16x16x32_bf16 v[80:83], v[148:151], v[116:119], v[80:83]
    v_exp_f32 v246, v70
    ds_read_b64_tr_b16 v[192:193], v236 offset:16384
    s_setprio 2
    v_mfma_f32_16x16x32_bf16 v[80:83], v[152:155], v[120:123], v[80:83]
    v_exp_f32 v247, v71
    v_mfma_f32_16x16x32_bf16 v[80:83], v[156:159], v[124:127], v[80:83]
    ds_read_b64_tr_b16 v[194:195], v236 offset:20480
    v_cvt_pk_bf16_f32 v100, v244, v245
    v_or3_b32 v248, v248, v99, v100
    v_mfma_f32_16x16x32_bf16 v[84:87], v[144:147], v[128:131], v[212:215]
    v_exp_f32 v242, v76
    ds_read_b64_tr_b16 v[196:197], v237 offset:16384
    v_mfma_f32_16x16x32_bf16 v[84:87], v[148:151], v[132:135], v[84:87]
    v_exp_f32 v243, v77
    ds_read_b64_tr_b16 v[198:199], v237 offset:20480
    v_mfma_f32_16x16x32_bf16 v[84:87], v[152:155], v[136:139], v[84:87]
    v_cvt_pk_bf16_f32 v101, v246, v247
    ds_read_b64_tr_b16 v[200:201], v238 offset:16384
    v_mfma_f32_16x16x32_bf16 v[84:87], v[156:159], v[140:143], v[84:87]
    v_exp_f32 v244, v78
    v_mfma_f32_16x16x32_bf16 v[88:91], v[160:163], v[112:115], v[208:211]
    ds_read_b64_tr_b16 v[202:203], v238 offset:20480
    v_exp_f32 v245, v79
    v_mfma_f32_16x16x32_bf16 v[88:91], v[164:167], v[116:119], v[88:91]
    v_cvt_pk_bf16_f32 v102, v242, v243
    ds_read_b64_tr_b16 v[204:205], v239 offset:16384
    v_mfma_f32_16x16x32_bf16 v[88:91], v[168:171], v[120:123], v[88:91]
    v_or3_b32 v248, v248, v101, v102
    v_cvt_pk_bf16_f32 v103, v244, v245
    ds_read_b64_tr_b16 v[206:207], v239 offset:20480
    v_mfma_f32_16x16x32_bf16 v[88:91], v[172:175], v[124:127], v[88:91]
    v_or_b32 v248, v248, v103
    v_and_b32 v248, 0x40004000, v248
    v_mfma_f32_16x16x32_bf16 v[92:95], v[160:163], v[128:131], v[212:215]
    v_cmp_ne_u32 vcc, 0, v248
    v_mfma_f32_16x16x32_bf16 v[92:95], v[164:167], v[132:135], v[92:95]
    v_mfma_f32_16x16x32_bf16 v[92:95], v[168:171], v[136:139], v[92:95]
    v_mfma_f32_16x16x32_bf16 v[92:95], v[172:175], v[140:143], v[92:95]
    s_cbranch_vccnz TR_26
BK_26:
STEP_27:
    s_waitcnt lgkmcnt(0)
    s_setprio 1
    v_mfma_f32_16x16x32_bf16 v[0:3], v[176:179], v[96:99], v[0:3]
    ds_read_b128 v[144:147], v228 offset:40960
    s_cmp_eq_u32 s0, 0
    s_cbranch_scc0 BU27V
    s_add_u32 m0, s72, 114688
    s_add_u32 s26, s72, 245760
    buffer_load_dwordx4 v241, s[36:39], s26 offen offset:0 nt lds
    v_xor_b32 v251, 128, v241
    buffer_load_dwordx4 v251, s[36:39], s26 offen offset:1024 nt lds
    buffer_load_dwordx4 v241, s[36:39], s26 offen offset:2048 nt lds
    v_xor_b32 v251, 128, v241
    buffer_load_dwordx4 v251, s[36:39], s26 offen offset:3072 nt lds
BU27V:
    v_mfma_f32_16x16x32_bf16 v[4:7], v[176:179], v[100:103], v[4:7]
    ds_read_b128 v[148:151], v229 offset:40960
    v_mfma_f32_16x16x32_bf16 v[8:11], v[180:183], v[96:99], v[8:11]
    ds_read_b128 v[152:155], v230 offset:40960
    v_mfma_f32_16x16x32_bf16 v[12:15], v[180:183], v[100:103], v[12:15]
    v_exp_f32 v242, v80
    v_mfma_f32_16x16x32_bf16 v[16:19], v[184:187], v[96:99], v[16:19]
    ds_read_b128 v[156:159], v231 offset:40960
    ds_read_b128 v[160:163], v228 offset:45056
    v_mfma_f32_16x16x32_bf16 v[20:23], v[184:187], v[100:103], v[20:23]
    v_exp_f32 v243, v81
    v_mfma_f32_16x16x32_bf16 v[24:27], v[188:191], v[96:99], v[24:27]
    v_exp_f32 v244, v82
    v_mfma_f32_16x16x32_bf16 v[28:31], v[188:191], v[100:103], v[28:31]
    ds_read_b128 v[164:167], v229 offset:45056
    ds_read_b128 v[168:171], v230 offset:45056
    v_mfma_f32_16x16x32_bf16 v[32:35], v[192:195], v[96:99], v[32:35]
    v_exp_f32 v245, v83
    v_mfma_f32_16x16x32_bf16 v[36:39], v[192:195], v[100:103], v[36:39]
    v_cvt_pk_bf16_f32 v104, v242, v243
    ds_read_b128 v[172:175], v231 offset:45056
    ds_read_b64_tr_b16 v[176:177], v232 offset:24576
    v_mfma_f32_16x16x32_bf16 v[40:43], v[196:199], v[96:99], v[40:43]
    v_exp_f32 v246, v88
    v_mfma_f32_16x16x32_bf16 v[44:47], v[196:199], v[100:103], v[44:47]
    v_exp_f32 v247, v89
    ds_read_b64_tr_b16 v[178:179], v232 offset:28672
    v_mfma_f32_16x16x32_bf16 v[48:51], v[200:203], v[96:99], v[48:51]
    v_cvt_pk_bf16_f32 v105, v244, v245
    ds_read_b64_tr_b16 v[180:181], v233 offset:24576
    v_exp_f32 v242, v90
    v_mfma_f32_16x16x32_bf16 v[52:55], v[200:203], v[100:103], v[52:55]
    ds_read_b64_tr_b16 v[182:183], v233 offset:28672
    v_exp_f32 v243, v91
    v_mfma_f32_16x16x32_bf16 v[56:59], v[204:207], v[96:99], v[56:59]
    ds_read_b64_tr_b16 v[184:185], v234 offset:24576
    v_mfma_f32_16x16x32_bf16 v[60:63], v[204:207], v[100:103], v[60:63]
    v_cvt_pk_bf16_f32 v106, v246, v247
    v_or3_b32 v248, v104, v105, v106
    v_mfma_f32_16x16x32_bf16 v[216:219], v[224:227], v[96:99], v[216:219]
    v_exp_f32 v244, v84
    ds_read_b64_tr_b16 v[186:187], v234 offset:28672
    v_mfma_f32_16x16x32_bf16 v[220:223], v[224:227], v[100:103], v[220:223]
    v_exp_f32 v245, v85
    ds_read_b64_tr_b16 v[188:189], v235 offset:24576
    s_waitcnt lgkmcnt(7)
    v_mfma_f32_16x16x32_bf16 v[64:67], v[144:147], v[112:115], v[208:211]
    v_cvt_pk_bf16_f32 v107, v242, v243
    ds_read_b64_tr_b16 v[190:191], v235 offset:28672
    v_mfma_f32_16x16x32_bf16 v[64:67], v[148:151], v[116:119], v[64:67]
    v_exp_f32 v246, v86
    ds_read_b64_tr_b16 v[192:193], v236 offset:24576
    s_setprio 0
    v_mfma_f32_16x16x32_bf16 v[64:67], v[152:155], v[120:123], v[64:67]
    v_exp_f32 v247, v87
    v_mfma_f32_16x16x32_bf16 v[64:67], v[156:159], v[124:127], v[64:67]
    ds_read_b64_tr_b16 v[194:195], v236 offset:28672
    v_cvt_pk_bf16_f32 v108, v244, v245
    v_or3_b32 v248, v248, v107, v108
    v_mfma_f32_16x16x32_bf16 v[68:71], v[144:147], v[128:131], v[212:215]
    v_exp_f32 v242, v92
    ds_read_b64_tr_b16 v[196:197], v237 offset:24576
    v_mfma_f32_16x16x32_bf16 v[68:71], v[148:151], v[132:135], v[68:71]
    v_exp_f32 v243, v93
    ds_read_b64_tr_b16 v[198:199], v237 offset:28672
    v_mfma_f32_16x16x32_bf16 v[68:71], v[152:155], v[136:139], v[68:71]
    v_cvt_pk_bf16_f32 v109, v246, v247
    ds_read_b64_tr_b16 v[200:201], v238 offset:24576
    v_mfma_f32_16x16x32_bf16 v[68:71], v[156:159], v[140:143], v[68:71]
    v_exp_f32 v244, v94
    v_mfma_f32_16x16x32_bf16 v[72:75], v[160:163], v[112:115], v[208:211]
    ds_read_b64_tr_b16 v[202:203], v238 offset:28672
    v_exp_f32 v245, v95
    v_mfma_f32_16x16x32_bf16 v[72:75], v[164:167], v[116:119], v[72:75]
    v_cvt_pk_bf16_f32 v110, v242, v243
    ds_read_b64_tr_b16 v[204:205], v239 offset:24576
    v_mfma_f32_16x16x32_bf16 v[72:75], v[168:171], v[120:123], v[72:75]
    v_or3_b32 v248, v248, v109, v110
    v_cvt_pk_bf16_f32 v111, v244, v245
    ds_read_b64_tr_b16 v[206:207], v239 offset:28672
    v_mfma_f32_16x16x32_bf16 v[72:75], v[172:175], v[124:127], v[72:75]
    v_or_b32 v248, v248, v111
    v_and_b32 v248, 0x40004000, v248
    v_mfma_f32_16x16x32_bf16 v[76:79], v[160:163], v[128:131], v[212:215]
    v_cmp_ne_u32 vcc, 0, v248
    v_mfma_f32_16x16x32_bf16 v[76:79], v[164:167], v[132:135], v[76:79]
    v_mfma_f32_16x16x32_bf16 v[76:79], v[168:171], v[136:139], v[76:79]
    v_mfma_f32_16x16x32_bf16 v[76:79], v[172:175], v[140:143], v[76:79]
    s_cbranch_vccnz TR_27
BK_27:
STEP_28:
    s_waitcnt vmcnt(4) lgkmcnt(0)
    s_barrier
    s_setprio 0
    v_mfma_f32_16x16x32_bf16 v[0:3], v[176:179], v[104:107], v[0:3]
    ds_read_b128 v[144:147], v228 offset:49152
    s_cmp_eq_u32 s0, 0
    s_cbranch_scc0 BU28K
    s_cmp_lt_u32 s72, 8192
    s_cbranch_scc0 BU28K
    s_add_u32 m0, s72, 0
    s_add_u32 s26, s72, 253952
    buffer_load_dwordx4 v240, s[32:35], s26 offen offset:0 nt lds
    v_xor_b32 v251, 64, v240
    buffer_load_dwordx4 v251, s[32:35], s26 offen offset:1024 nt lds
    v_xor_b32 v250, 128, v240
    buffer_load_dwordx4 v250, s[32:35], s26 offen offset:2048 nt lds
    v_xor_b32 v251, 192, v240
    buffer_load_dwordx4 v251, s[32:35], s26 offen offset:3072 nt lds
BU28K:
    v_mfma_f32_16x16x32_bf16 v[4:7], v[176:179], v[108:111], v[4:7]
    ds_read_b128 v[148:151], v229 offset:49152
    v_mfma_f32_16x16x32_bf16 v[8:11], v[180:183], v[104:107], v[8:11]
    ds_read_b128 v[152:155], v230 offset:49152
    v_mfma_f32_16x16x32_bf16 v[12:15], v[180:183], v[108:111], v[12:15]
    v_exp_f32 v242, v64
    v_mfma_f32_16x16x32_bf16 v[16:19], v[184:187], v[104:107], v[16:19]
    ds_read_b128 v[156:159], v231 offset:49152
    ds_read_b128 v[160:163], v228 offset:53248
    v_mfma_f32_16x16x32_bf16 v[20:23], v[184:187], v[108:111], v[20:23]
    v_exp_f32 v243, v65
    v_mfma_f32_16x16x32_bf16 v[24:27], v[188:191], v[104:107], v[24:27]
    v_exp_f32 v244, v66
    v_mfma_f32_16x16x32_bf16 v[28:31], v[188:191], v[108:111], v[28:31]
    ds_read_b128 v[164:167], v229 offset:53248
    ds_read_b128 v[168:171], v230 offset:53248
    v_mfma_f32_16x16x32_bf16 v[32:35], v[192:195], v[104:107], v[32:35]
    v_exp_f32 v245, v67
    v_mfma_f32_16x16x32_bf16 v[36:39], v[192:195], v[108:111], v[36:39]
    v_cvt_pk_bf16_f32 v96, v242, v243
    ds_read_b128 v[172:175], v231 offset:53248
    ds_read_b64_tr_b16 v[176:177], v232 offset:32768
    v_mfma_f32_16x16x32_bf16 v[40:43], v[196:199], v[104:107], v[40:43]
    v_exp_f32 v246, v72
    v_mfma_f32_16x16x32_bf16 v[44:47], v[196:199], v[108:111], v[44:47]
    v_exp_f32 v247, v73
    ds_read_b64_tr_b16 v[178:179], v232 offset:36864
    v_mfma_f32_16x16x32_bf16 v[48:51], v[200:203], v[104:107], v[48:51]
    v_cvt_pk_bf16_f32 v97, v244, v245
    ds_read_b64_tr_b16 v[180:181], v233 offset:32768
    v_exp_f32 v242, v74
    v_mfma_f32_16x16x32_bf16 v[52:55], v[200:203], v[108:111], v[52:55]
    ds_read_b64_tr_b16 v[182:183], v233 offset:36864
    v_exp_f32 v243, v75
    v_mfma_f32_16x16x32_bf16 v[56:59], v[204:207], v[104:107], v[56:59]
    ds_read_b64_tr_b16 v[184:185], v234 offset:32768
    v_mfma_f32_16x16x32_bf16 v[60:63], v[204:207], v[108:111], v[60:63]
    v_cvt_pk_bf16_f32 v98, v246, v247
    v_or3_b32 v248, v96, v97, v98
    v_mfma_f32_16x16x32_bf16 v[216:219], v[224:227], v[104:107], v[216:219]
    v_exp_f32 v244, v68
    ds_read_b64_tr_b16 v[186:187], v234 offset:36864
    v_mfma_f32_16x16x32_bf16 v[220:223], v[224:227], v[108:111], v[220:223]
    v_exp_f32 v245, v69
    ds_read_b64_tr_b16 v[188:189], v235 offset:32768
    s_waitcnt lgkmcnt(7)
    v_mfma_f32_16x16x32_bf16 v[80:83], v[144:147], v[112:115], v[208:211]
    v_cvt_pk_bf16_f32 v99, v242, v243
    ds_read_b64_tr_b16 v[190:191], v235 offset:36864
    v_mfma_f32_16x16x32_bf16 v[80:83], v[148:151], v[116:119], v[80:83]
    v_exp_f32 v246, v70
    ds_read_b64_tr_b16 v[192:193], v236 offset:32768
    v_mfma_f32_16x16x32_bf16 v[80:83], v[152:155], v[120:123], v[80:83]
    v_exp_f32 v247, v71
    v_mfma_f32_16x16x32_bf16 v[80:83], v[156:159], v[124:127], v[80:83]
    ds_read_b64_tr_b16 v[194:195], v236 offset:36864
    v_cvt_pk_bf16_f32 v100, v244, v245
    v_or3_b32 v248, v248, v99, v100
    v_mfma_f32_16x16x32_bf16 v[84:87], v[144:147], v[128:131], v[212:215]
    v_exp_f32 v242, v76
    ds_read_b64_tr_b16 v[196:197], v237 offset:32768
    v_mfma_f32_16x16x32_bf16 v[84:87], v[148:151], v[132:135], v[84:87]
    v_exp_f32 v243, v77
    ds_read_b64_tr_b16 v[198:199], v237 offset:36864
    v_mfma_f32_16x16x32_bf16 v[84:87], v[152:155], v[136:139], v[84:87]
    v_cvt_pk_bf16_f32 v101, v246, v247
    ds_read_b64_tr_b16 v[200:201], v238 offset:32768
    v_mfma_f32_16x16x32_bf16 v[84:87], v[156:159], v[140:143], v[84:87]
    v_exp_f32 v244, v78
    v_mfma_f32_16x16x32_bf16 v[88:91], v[160:163], v[112:115], v[208:211]
    ds_read_b64_tr_b16 v[202:203], v238 offset:36864
    v_exp_f32 v245, v79
    v_mfma_f32_16x16x32_bf16 v[88:91], v[164:167], v[116:119], v[88:91]
    v_cvt_pk_bf16_f32 v102, v242, v243
    ds_read_b64_tr_b16 v[204:205], v239 offset:32768
    v_mfma_f32_16x16x32_bf16 v[88:91], v[168:171], v[120:123], v[88:91]
    v_or3_b32 v248, v248, v101, v102
    v_cvt_pk_bf16_f32 v103, v244, v245
    ds_read_b64_tr_b16 v[206:207], v239 offset:36864
    v_mfma_f32_16x16x32_bf16 v[88:91], v[172:175], v[124:127], v[88:91]
    v_or_b32 v248, v248, v103
    v_and_b32 v248, 0x40004000, v248
    v_mfma_f32_16x16x32_bf16 v[92:95], v[160:163], v[128:131], v[212:215]
    v_cmp_ne_u32 vcc, 0, v248
    v_mfma_f32_16x16x32_bf16 v[92:95], v[164:167], v[132:135], v[92:95]
    v_mfma_f32_16x16x32_bf16 v[92:95], v[168:171], v[136:139], v[92:95]
    v_mfma_f32_16x16x32_bf16 v[92:95], v[172:175], v[140:143], v[92:95]
    s_cbranch_vccnz TR_28
BK_28:
STEP_29:
    s_waitcnt lgkmcnt(0)
    v_mfma_f32_16x16x32_bf16 v[0:3], v[176:179], v[96:99], v[0:3]
    ds_read_b128 v[144:147], v228 offset:57344
    v_mfma_f32_16x16x32_bf16 v[4:7], v[176:179], v[100:103], v[4:7]
    ds_read_b128 v[148:151], v229 offset:57344
    v_mfma_f32_16x16x32_bf16 v[8:11], v[180:183], v[96:99], v[8:11]
    ds_read_b128 v[152:155], v230 offset:57344
    v_mfma_f32_16x16x32_bf16 v[12:15], v[180:183], v[100:103], v[12:15]
    v_exp_f32 v242, v80
    v_mfma_f32_16x16x32_bf16 v[16:19], v[184:187], v[96:99], v[16:19]
    ds_read_b128 v[156:159], v231 offset:57344
    ds_read_b128 v[160:163], v228 offset:61440
    v_mfma_f32_16x16x32_bf16 v[20:23], v[184:187], v[100:103], v[20:23]
    v_exp_f32 v243, v81
    v_mfma_f32_16x16x32_bf16 v[24:27], v[188:191], v[96:99], v[24:27]
    v_exp_f32 v244, v82
    v_mfma_f32_16x16x32_bf16 v[28:31], v[188:191], v[100:103], v[28:31]
    ds_read_b128 v[164:167], v229 offset:61440
    ds_read_b128 v[168:171], v230 offset:61440
    v_mfma_f32_16x16x32_bf16 v[32:35], v[192:195], v[96:99], v[32:35]
    v_exp_f32 v245, v83
    v_mfma_f32_16x16x32_bf16 v[36:39], v[192:195], v[100:103], v[36:39]
    v_cvt_pk_bf16_f32 v104, v242, v243
    ds_read_b128 v[172:175], v231 offset:61440
    ds_read_b64_tr_b16 v[176:177], v232 offset:40960
    v_mfma_f32_16x16x32_bf16 v[40:43], v[196:199], v[96:99], v[40:43]
    v_exp_f32 v246, v88
    v_mfma_f32_16x16x32_bf16 v[44:47], v[196:199], v[100:103], v[44:47]
    v_exp_f32 v247, v89
    ds_read_b64_tr_b16 v[178:179], v232 offset:45056
    v_mfma_f32_16x16x32_bf16 v[48:51], v[200:203], v[96:99], v[48:51]
    v_cvt_pk_bf16_f32 v105, v244, v245
    ds_read_b64_tr_b16 v[180:181], v233 offset:40960
    v_exp_f32 v242, v90
    v_mfma_f32_16x16x32_bf16 v[52:55], v[200:203], v[100:103], v[52:55]
    ds_read_b64_tr_b16 v[182:183], v233 offset:45056
    v_exp_f32 v243, v91
    v_mfma_f32_16x16x32_bf16 v[56:59], v[204:207], v[96:99], v[56:59]
    ds_read_b64_tr_b16 v[184:185], v234 offset:40960
    v_mfma_f32_16x16x32_bf16 v[60:63], v[204:207], v[100:103], v[60:63]
    v_cvt_pk_bf16_f32 v106, v246, v247
    v_or3_b32 v248, v104, v105, v106
    v_mfma_f32_16x16x32_bf16 v[216:219], v[224:227], v[96:99], v[216:219]
    v_exp_f32 v244, v84
    ds_read_b64_tr_b16 v[186:187], v234 offset:45056
    v_mfma_f32_16x16x32_bf16 v[220:223], v[224:227], v[100:103], v[220:223]
    v_exp_f32 v245, v85
    ds_read_b64_tr_b16 v[188:189], v235 offset:40960
    s_waitcnt lgkmcnt(7)
    v_mfma_f32_16x16x32_bf16 v[64:67], v[144:147], v[112:115], v[208:211]
    v_cvt_pk_bf16_f32 v107, v242, v243
    ds_read_b64_tr_b16 v[190:191], v235 offset:45056
    v_mfma_f32_16x16x32_bf16 v[64:67], v[148:151], v[116:119], v[64:67]
    v_exp_f32 v246, v86
    ds_read_b64_tr_b16 v[192:193], v236 offset:40960
    v_mfma_f32_16x16x32_bf16 v[64:67], v[152:155], v[120:123], v[64:67]
    v_exp_f32 v247, v87
    v_mfma_f32_16x16x32_bf16 v[64:67], v[156:159], v[124:127], v[64:67]
    ds_read_b64_tr_b16 v[194:195], v236 offset:45056
    v_cvt_pk_bf16_f32 v108, v244, v245
    v_or3_b32 v248, v248, v107, v108
    v_mfma_f32_16x16x32_bf16 v[68:71], v[144:147], v[128:131], v[212:215]
    v_exp_f32 v242, v92
    ds_read_b64_tr_b16 v[196:197], v237 offset:40960
    v_mfma_f32_16x16x32_bf16 v[68:71], v[148:151], v[132:135], v[68:71]
    v_exp_f32 v243, v93
    ds_read_b64_tr_b16 v[198:199], v237 offset:45056
    v_mfma_f32_16x16x32_bf16 v[68:71], v[152:155], v[136:139], v[68:71]
    v_cvt_pk_bf16_f32 v109, v246, v247
    ds_read_b64_tr_b16 v[200:201], v238 offset:40960
    v_mfma_f32_16x16x32_bf16 v[68:71], v[156:159], v[140:143], v[68:71]
    v_exp_f32 v244, v94
    v_mfma_f32_16x16x32_bf16 v[72:75], v[160:163], v[112:115], v[208:211]
    ds_read_b64_tr_b16 v[202:203], v238 offset:45056
    v_exp_f32 v245, v95
    v_mfma_f32_16x16x32_bf16 v[72:75], v[164:167], v[116:119], v[72:75]
    v_cvt_pk_bf16_f32 v110, v242, v243
    ds_read_b64_tr_b16 v[204:205], v239 offset:40960
    v_mfma_f32_16x16x32_bf16 v[72:75], v[168:171], v[120:123], v[72:75]
    v_or3_b32 v248, v248, v109, v110
    v_cvt_pk_bf16_f32 v111, v244, v245
    ds_read_b64_tr_b16 v[206:207], v239 offset:45056
    v_mfma_f32_16x16x32_bf16 v[72:75], v[172:175], v[124:127], v[72:75]
    v_or_b32 v248, v248, v111
    v_and_b32 v248, 0x40004000, v248
    v_mfma_f32_16x16x32_bf16 v[76:79], v[160:163], v[128:131], v[212:215]
    v_cmp_ne_u32 vcc, 0, v248
    v_mfma_f32_16x16x32_bf16 v[76:79], v[164:167], v[132:135], v[76:79]
    v_mfma_f32_16x16x32_bf16 v[76:79], v[168:171], v[136:139], v[76:79]
    v_mfma_f32_16x16x32_bf16 v[76:79], v[172:175], v[140:143], v[76:79]
    s_cbranch_vccnz TR_29
BK_29:
STEP_30:
    s_waitcnt lgkmcnt(0)
    s_cmp_eq_u32 s0, 0
    s_cbranch_scc0 NB30
    s_waitcnt vmcnt(0)
    s_barrier
NB30:
    v_mfma_f32_16x16x32_bf16 v[0:3], v[176:179], v[104:107], v[0:3]
    ds_read_b128 v[144:147], v228 offset:0
    v_mfma_f32_16x16x32_bf16 v[4:7], v[176:179], v[108:111], v[4:7]
    ds_read_b128 v[148:151], v229 offset:0
    v_mfma_f32_16x16x32_bf16 v[8:11], v[180:183], v[104:107], v[8:11]
    ds_read_b128 v[152:155], v230 offset:0
    v_mfma_f32_16x16x32_bf16 v[12:15], v[180:183], v[108:111], v[12:15]
    v_exp_f32 v242, v64
    v_mfma_f32_16x16x32_bf16 v[16:19], v[184:187], v[104:107], v[16:19]
    ds_read_b128 v[156:159], v231 offset:0
    ds_read_b128 v[160:163], v228 offset:4096
    v_mfma_f32_16x16x32_bf16 v[20:23], v[184:187], v[108:111], v[20:23]
    v_exp_f32 v243, v65
    v_mfma_f32_16x16x32_bf16 v[24:27], v[188:191], v[104:107], v[24:27]
    v_exp_f32 v244, v66
    v_mfma_f32_16x16x32_bf16 v[28:31], v[188:191], v[108:111], v[28:31]
    ds_read_b128 v[164:167], v229 offset:4096
    ds_read_b128 v[168:171], v230 offset:4096
    v_mfma_f32_16x16x32_bf16 v[32:35], v[192:195], v[104:107], v[32:35]
    v_exp_f32 v245, v67
    v_mfma_f32_16x16x32_bf16 v[36:39], v[192:195], v[108:111], v[36:39]
    v_cvt_pk_bf16_f32 v96, v242, v243
    ds_read_b128 v[172:175], v231 offset:4096
    ds_read_b64_tr_b16 v[176:177], v232 offset:49152
    v_mfma_f32_16x16x32_bf16 v[40:43], v[196:199], v[104:107], v[40:43]
    v_exp_f32 v246, v72
    v_mfma_f32_16x16x32_bf16 v[44:47], v[196:199], v[108:111], v[44:47]
    v_exp_f32 v247, v73
    ds_read_b64_tr_b16 v[178:179], v232 offset:53248
    v_mfma_f32_16x16x32_bf16 v[48:51], v[200:203], v[104:107], v[48:51]
    v_cvt_pk_bf16_f32 v97, v244, v245
    ds_read_b64_tr_b16 v[180:181], v233 offset:49152
    v_exp_f32 v242, v74
    v_mfma_f32_16x16x32_bf16 v[52:55], v[200:203], v[108:111], v[52:55]
    ds_read_b64_tr_b16 v[182:183], v233 offset:53248
    v_exp_f32 v243, v75
    v_mfma_f32_16x16x32_bf16 v[56:59], v[204:207], v[104:107], v[56:59]
    ds_read_b64_tr_b16 v[184:185], v234 offset:49152
    v_mfma_f32_16x16x32_bf16 v[60:63], v[204:207], v[108:111], v[60:63]
    v_cvt_pk_bf16_f32 v98, v246, v247
    v_or3_b32 v248, v96, v97, v98
    v_mfma_f32_16x16x32_bf16 v[216:219], v[224:227], v[104:107], v[216:219]
    v_exp_f32 v244, v68
    ds_read_b64_tr_b16 v[186:187], v234 offset:53248
    v_mfma_f32_16x16x32_bf16 v[220:223], v[224:227], v[108:111], v[220:223]
    v_exp_f32 v245, v69
    ds_read_b64_tr_b16 v[188:189], v235 offset:49152
    s_waitcnt lgkmcnt(7)
    v_mfma_f32_16x16x32_bf16 v[80:83], v[144:147], v[112:115], v[208:211]
    v_cvt_pk_bf16_f32 v99, v242, v243
    ds_read_b64_tr_b16 v[190:191], v235 offset:53248
    v_mfma_f32_16x16x32_bf16 v[80:83], v[148:151], v[116:119], v[80:83]
    v_exp_f32 v246, v70
    ds_read_b64_tr_b16 v[192:193], v236 offset:49152
    v_mfma_f32_16x16x32_bf16 v[80:83], v[152:155], v[120:123], v[80:83]
    v_exp_f32 v247, v71
    v_mfma_f32_16x16x32_bf16 v[80:83], v[156:159], v[124:127], v[80:83]
    ds_read_b64_tr_b16 v[194:195], v236 offset:53248
    v_cvt_pk_bf16_f32 v100, v244, v245
    v_or3_b32 v248, v248, v99, v100
    v_mfma_f32_16x16x32_bf16 v[84:87], v[144:147], v[128:131], v[212:215]
    v_exp_f32 v242, v76
    ds_read_b64_tr_b16 v[196:197], v237 offset:49152
    v_mfma_f32_16x16x32_bf16 v[84:87], v[148:151], v[132:135], v[84:87]
    v_exp_f32 v243, v77
    ds_read_b64_tr_b16 v[198:199], v237 offset:53248
    v_mfma_f32_16x16x32_bf16 v[84:87], v[152:155], v[136:139], v[84:87]
    v_cvt_pk_bf16_f32 v101, v246, v247
    ds_read_b64_tr_b16 v[200:201], v238 offset:49152
    v_mfma_f32_16x16x32_bf16 v[84:87], v[156:159], v[140:143], v[84:87]
    v_exp_f32 v244, v78
    v_mfma_f32_16x16x32_bf16 v[88:91], v[160:163], v[112:115], v[208:211]
    ds_read_b64_tr_b16 v[202:203], v238 offset:53248
    v_exp_f32 v245, v79
    v_mfma_f32_16x16x32_bf16 v[88:91], v[164:167], v[116:119], v[88:91]
    v_cvt_pk_bf16_f32 v102, v242, v243
    ds_read_b64_tr_b16 v[204:205], v239 offset:49152
    v_mfma_f32_16x16x32_bf16 v[88:91], v[168:171], v[120:123], v[88:91]
    v_or3_b32 v248, v248, v101, v102
    v_cvt_pk_bf16_f32 v103, v244, v245
    ds_read_b64_tr_b16 v[206:207], v239 offset:53248
    v_mfma_f32_16x16x32_bf16 v[88:91], v[172:175], v[124:127], v[88:91]
    v_or_b32 v248, v248, v103
    v_and_b32 v248, 0x40004000, v248
    v_mfma_f32_16x16x32_bf16 v[92:95], v[160:163], v[128:131], v[212:215]
    v_cmp_ne_u32 vcc, 0, v248
    v_mfma_f32_16x16x32_bf16 v[92:95], v[164:167], v[132:135], v[92:95]
    v_mfma_f32_16x16x32_bf16 v[92:95], v[168:171], v[136:139], v[92:95]
    v_mfma_f32_16x16x32_bf16 v[92:95], v[172:175], v[140:143], v[92:95]
    s_cbranch_vccnz TR_30
BK_30:
STEP_31:
    s_waitcnt lgkmcnt(0)
    v_mfma_f32_16x16x32_bf16 v[0:3], v[176:179], v[96:99], v[0:3]
    v_mfma_f32_16x16x32_bf16 v[4:7], v[176:179], v[100:103], v[4:7]
    ds_read_b64_tr_b16 v[176:177], v232 offset:57344
    ds_read_b64_tr_b16 v[178:179], v232 offset:61440
    v_mfma_f32_16x16x32_bf16 v[8:11], v[180:183], v[96:99], v[8:11]
    v_exp_f32 v242, v80
    v_exp_f32 v243, v81
    v_mfma_f32_16x16x32_bf16 v[12:15], v[180:183], v[100:103], v[12:15]
    v_exp_f32 v244, v82
    ds_read_b64_tr_b16 v[180:181], v233 offset:57344
    ds_read_b64_tr_b16 v[182:183], v233 offset:61440
    v_mfma_f32_16x16x32_bf16 v[16:19], v[184:187], v[96:99], v[16:19]
    v_exp_f32 v245, v83
    v_cvt_pk_bf16_f32 v104, v242, v243
    v_exp_f32 v246, v88
    v_mfma_f32_16x16x32_bf16 v[20:23], v[184:187], v[100:103], v[20:23]
    v_exp_f32 v247, v89
    v_cvt_pk_bf16_f32 v105, v244, v245
    ds_read_b64_tr_b16 v[184:185], v234 offset:57344
    v_mfma_f32_16x16x32_bf16 v[24:27], v[188:191], v[96:99], v[24:27]
    ds_read_b64_tr_b16 v[186:187], v234 offset:61440
    v_exp_f32 v242, v90
    v_exp_f32 v243, v91
    v_mfma_f32_16x16x32_bf16 v[28:31], v[188:191], v[100:103], v[28:31]
    v_cvt_pk_bf16_f32 v106, v246, v247
    v_or3_b32 v248, v104, v105, v106
    v_exp_f32 v244, v84
    v_mfma_f32_16x16x32_bf16 v[32:35], v[192:195], v[96:99], v[32:35]
    v_exp_f32 v245, v85
    ds_read_b64_tr_b16 v[188:189], v235 offset:57344
    ds_read_b64_tr_b16 v[190:191], v235 offset:61440
    v_mfma_f32_16x16x32_bf16 v[36:39], v[192:195], v[100:103], v[36:39]
    v_cvt_pk_bf16_f32 v107, v242, v243
    v_exp_f32 v246, v86
    v_exp_f32 v247, v87
    v_mfma_f32_16x16x32_bf16 v[40:43], v[196:199], v[96:99], v[40:43]
    v_cvt_pk_bf16_f32 v108, v244, v245
    v_or3_b32 v248, v248, v107, v108
    v_exp_f32 v242, v92
    v_mfma_f32_16x16x32_bf16 v[44:47], v[196:199], v[100:103], v[44:47]
    ds_read_b64_tr_b16 v[192:193], v236 offset:57344
    ds_read_b64_tr_b16 v[194:195], v236 offset:61440
    v_exp_f32 v243, v93
    v_mfma_f32_16x16x32_bf16 v[48:51], v[200:203], v[96:99], v[48:51]
    v_cvt_pk_bf16_f32 v109, v246, v247
    v_exp_f32 v244, v94
    v_exp_f32 v245, v95
    v_mfma_f32_16x16x32_bf16 v[52:55], v[200:203], v[100:103], v[52:55]
    v_cvt_pk_bf16_f32 v110, v242, v243
    v_or3_b32 v248, v248, v109, v110
    ds_read_b64_tr_b16 v[196:197], v237 offset:57344
    ds_read_b64_tr_b16 v[198:199], v237 offset:61440
    v_mfma_f32_16x16x32_bf16 v[56:59], v[204:207], v[96:99], v[56:59]
    v_cvt_pk_bf16_f32 v111, v244, v245
    v_or_b32 v248, v248, v111
    v_and_b32 v248, 0x40004000, v248
    v_cmp_ne_u32 vcc, 0, v248
    v_mfma_f32_16x16x32_bf16 v[60:63], v[204:207], v[100:103], v[60:63]
    ds_read_b64_tr_b16 v[200:201], v238 offset:57344
    ds_read_b64_tr_b16 v[202:203], v238 offset:61440
    ds_read_b64_tr_b16 v[204:205], v239 offset:57344
    ds_read_b64_tr_b16 v[206:207], v239 offset:61440
    v_mfma_f32_16x16x32_bf16 v[216:219], v[224:227], v[96:99], v[216:219]
    v_mfma_f32_16x16x32_bf16 v[220:223], v[224:227], v[100:103], v[220:223]
    s_cbranch_vccnz TR_31
BK_31:
EPI:
    s_waitcnt lgkmcnt(0)
    s_cmp_eq_u32 s24, s23
    s_cbranch_scc1 OWN
    v_mov_b32 v251, 155648
    ds_read_b32 v253, v251
    s_lshl_b32 s28, s24, 3
    s_add_u32 s28, s28, s23
    s_lshl_b32 s29, s28, 13
    s_add_u32 s30, s29, 4096
    s_lshl_b32 s31, s28, 8
    s_add_u32 s31, s31, 524288
    v_lshlrev_b32 v250, 4, v249
    v_mfma_f32_16x16x32_bf16 v[0:3], v[176:179], v[104:107], v[0:3]
    v_mfma_f32_16x16x32_bf16 v[8:11], v[180:183], v[104:107], v[8:11]
    v_mfma_f32_16x16x32_bf16 v[16:19], v[184:187], v[104:107], v[16:19]
    v_mfma_f32_16x16x32_bf16 v[24:27], v[188:191], v[104:107], v[24:27]
    v_mfma_f32_16x16x32_bf16 v[32:35], v[192:195], v[104:107], v[32:35]
    v_mfma_f32_16x16x32_bf16 v[40:43], v[196:199], v[104:107], v[40:43]
    v_mfma_f32_16x16x32_bf16 v[48:51], v[200:203], v[104:107], v[48:51]
    v_mfma_f32_16x16x32_bf16 v[56:59], v[204:207], v[104:107], v[56:59]
    v_mfma_f32_16x16x32_bf16 v[4:7], v[176:179], v[108:111], v[4:7]
    v_mfma_f32_16x16x32_bf16 v[12:15], v[180:183], v[108:111], v[12:15]
    v_cvt_pk_bf16_f32 v144, v0, v1
    v_cvt_pk_bf16_f32 v145, v2, v3
    v_cvt_pk_bf16_f32 v146, v8, v9
    v_cvt_pk_bf16_f32 v147, v10, v11
    buffer_store_dwordx4 v[144:147], v250, s[56:59], s29 offen offset:0 sc1
    v_mfma_f32_16x16x32_bf16 v[20:23], v[184:187], v[108:111], v[20:23]
    v_mfma_f32_16x16x32_bf16 v[28:31], v[188:191], v[108:111], v[28:31]
    v_cvt_pk_bf16_f32 v148, v16, v17
    v_cvt_pk_bf16_f32 v149, v18, v19
    v_cvt_pk_bf16_f32 v150, v24, v25
    v_cvt_pk_bf16_f32 v151, v26, v27
    buffer_store_dwordx4 v[148:151], v250, s[56:59], s29 offen offset:1024 sc1
    v_mfma_f32_16x16x32_bf16 v[36:39], v[192:195], v[108:111], v[36:39]
    v_mfma_f32_16x16x32_bf16 v[44:47], v[196:199], v[108:111], v[44:47]
    v_cvt_pk_bf16_f32 v152, v32, v33
    v_cvt_pk_bf16_f32 v153, v34, v35
    v_cvt_pk_bf16_f32 v154, v40, v41
    v_cvt_pk_bf16_f32 v155, v42, v43
    buffer_store_dwordx4 v[152:155], v250, s[56:59], s29 offen offset:2048 sc1
    v_mfma_f32_16x16x32_bf16 v[52:55], v[200:203], v[108:111], v[52:55]
    v_mfma_f32_16x16x32_bf16 v[60:63], v[204:207], v[108:111], v[60:63]
    v_cvt_pk_bf16_f32 v156, v48, v49
    v_cvt_pk_bf16_f32 v157, v50, v51
    v_cvt_pk_bf16_f32 v158, v56, v57
    v_cvt_pk_bf16_f32 v159, v58, v59
    buffer_store_dwordx4 v[156:159], v250, s[56:59], s29 offen offset:3072 sc1
    v_mfma_f32_16x16x32_bf16 v[216:219], v[224:227], v[104:107], v[216:219]
    v_mfma_f32_16x16x32_bf16 v[220:223], v[224:227], v[108:111], v[220:223]
    v_cvt_pk_bf16_f32 v160, v4, v5
    v_cvt_pk_bf16_f32 v161, v6, v7
    v_cvt_pk_bf16_f32 v162, v12, v13
    v_cvt_pk_bf16_f32 v163, v14, v15
    buffer_store_dwordx4 v[160:163], v250, s[56:59], s30 offen offset:0 sc1
    v_cvt_pk_bf16_f32 v164, v20, v21
    v_cvt_pk_bf16_f32 v165, v22, v23
    v_cvt_pk_bf16_f32 v166, v28, v29
    v_cvt_pk_bf16_f32 v167, v30, v31
    buffer_store_dwordx4 v[164:167], v250, s[56:59], s30 offen offset:1024 sc1
    v_cvt_pk_bf16_f32 v168, v36, v37
    v_cvt_pk_bf16_f32 v169, v38, v39
    v_cvt_pk_bf16_f32 v170, v44, v45
    v_cvt_pk_bf16_f32 v171, v46, v47
    buffer_store_dwordx4 v[168:171], v250, s[56:59], s30 offen offset:2048 sc1
    v_cvt_pk_bf16_f32 v172, v52, v53
    v_cvt_pk_bf16_f32 v173, v54, v55
    v_cvt_pk_bf16_f32 v174, v60, v61
    v_cvt_pk_bf16_f32 v175, v62, v63
    buffer_store_dwordx4 v[172:175], v250, s[56:59], s30 offen offset:3072 sc1
    v_mov_b32 v210, v212
    v_mov_b32 v209, v216
    v_mov_b32 v211, v220
    s_mov_b32 s30, 131072
    s_waitcnt lgkmcnt(0)
    v_cmp_le_u32 vcc, 8, v253
    s_cbranch_vccnz RDY_OK
RDY:
    buffer_load_dword v254, off, s[68:71], s75 sc1
    s_waitcnt vmcnt(0)
    v_cmp_le_u32 vcc, 8, v254
    s_cbranch_vccnz RDY_OK
    s_sub_u32 s30, s30, 1
    s_cbranch_scc1 RDY_OK
    s_sleep 32
    s_branch RDY
RDY_OK:
    s_waitcnt vmcnt(0)
    s_mov_b64 exec, 0xffff
    buffer_store_dwordx4 v[208:211], v250, s[56:59], s31 offen sc1
    s_mov_b64 exec, -1
    s_barrier
    s_lshl_b32 s29, s24, 10
    s_lshl_b32 s28, s23, 16
    v_lshlrev_b32 v123, 4, v249
    v_add_u32 v123, s29, v123
    v_add_u32 v120, s28, v123
    s_lshl_b32 s28, s23, 13
    s_add_u32 s28, s28, 8192
    s_and_b32 s28, s28, 0xffff
    buffer_load_dwordx4 v[68:71], v120, s[56:59], s28 offen sc1
    s_add_u32 s28, s28, 8192
    s_and_b32 s28, s28, 0xffff
    buffer_load_dwordx4 v[72:75], v120, s[56:59], s28 offen sc1
    s_add_u32 s28, s28, 8192
    s_and_b32 s28, s28, 0xffff
    buffer_load_dwordx4 v[76:79], v120, s[56:59], s28 offen sc1
    s_add_u32 s28, s28, 8192
    s_and_b32 s28, s28, 0xffff
    buffer_load_dwordx4 v[80:83], v120, s[56:59], s28 offen sc1
    s_add_u32 s28, s28, 8192
    s_and_b32 s28, s28, 0xffff
    buffer_load_dwordx4 v[84:87], v120, s[56:59], s28 offen sc1
    s_add_u32 s28, s28, 8192
    s_and_b32 s28, s28, 0xffff
    buffer_load_dwordx4 v[88:91], v120, s[56:59], s28 offen sc1
    s_add_u32 s28, s28, 8192
    s_and_b32 s28, s28, 0xffff
    buffer_load_dwordx4 v[92:95], v120, s[56:59], s28 offen sc1
    v_add_u32 v123, 131072, v123
    ds_read_b128 v[64:67], v123
COMB:
    s_lshr_b32 s30, s24, 2
    s_lshl_b32 s29, s30, 9
    s_add_u32 s29, s29, 140288
    v_and_b32 v121, 15, v249
    v_lshlrev_b32 v122, 5, v121
    v_add_u32 v122, s29, v122
    s_waitcnt lgkmcnt(0)
    s_barrier
    ds_read_b128 v[100:103], v122
    ds_read_b128 v[104:107], v122 offset:16
    v_lshrrev_b32 v124, 4, v249
    v_lshlrev_b32 v124, 3, v124
    v_lshl_add_u32 v121, v121, 6, v124
    s_lshl_b32 s29, s24, 10
    v_add_u32 v121, s29, v121
    v_lshlrev_b32 v122, 4, v249
    v_add_u32 v122, s29, v122
    v_lshrrev_b32 v124, 2, v249
    v_and_b32 v125, 3, v249
    v_lshlrev_b32 v125, 4, v125
    v_lshl_add_u32 v120, v124, 8, v125
    s_lshl_b32 s30, s30, 12
    s_and_b32 s29, s24, 3
    s_lshl_b32 s29, s29, 6
    s_add_u32 s29, s29, s30
    s_waitcnt lgkmcnt(0)
    v_lshlrev_b32 v124, 16, v64
    v_and_b32 v125, 0xffff0000, v64
    v_mul_f32 v110, v100, v124
    v_mul_f32 v111, v100, v125
    v_lshlrev_b32 v124, 16, v65
    v_and_b32 v125, 0xffff0000, v65
    v_mul_f32 v112, v100, v124
    v_mul_f32 v113, v100, v125
    v_lshlrev_b32 v124, 16, v66
    v_and_b32 v125, 0xffff0000, v66
    v_mul_f32 v114, v100, v124
    v_mul_f32 v115, v100, v125
    v_lshlrev_b32 v124, 16, v67
    v_and_b32 v125, 0xffff0000, v67
    v_mul_f32 v116, v100, v124
    v_mul_f32 v117, v100, v125
    s_waitcnt vmcnt(6)
    v_lshlrev_b32 v124, 16, v68
    v_and_b32 v125, 0xffff0000, v68
    v_fmac_f32 v110, v101, v124
    v_fmac_f32 v111, v101, v125
    v_lshlrev_b32 v124, 16, v69
    v_and_b32 v125, 0xffff0000, v69
    v_fmac_f32 v112, v101, v124
    v_fmac_f32 v113, v101, v125
    v_lshlrev_b32 v124, 16, v70
    v_and_b32 v125, 0xffff0000, v70
    v_fmac_f32 v114, v101, v124
    v_fmac_f32 v115, v101, v125
    v_lshlrev_b32 v124, 16, v71
    v_and_b32 v125, 0xffff0000, v71
    v_fmac_f32 v116, v101, v124
    v_fmac_f32 v117, v101, v125
    s_waitcnt vmcnt(5)
    v_lshlrev_b32 v124, 16, v72
    v_and_b32 v125, 0xffff0000, v72
    v_fmac_f32 v110, v102, v124
    v_fmac_f32 v111, v102, v125
    v_lshlrev_b32 v124, 16, v73
    v_and_b32 v125, 0xffff0000, v73
    v_fmac_f32 v112, v102, v124
    v_fmac_f32 v113, v102, v125
    v_lshlrev_b32 v124, 16, v74
    v_and_b32 v125, 0xffff0000, v74
    v_fmac_f32 v114, v102, v124
    v_fmac_f32 v115, v102, v125
    v_lshlrev_b32 v124, 16, v75
    v_and_b32 v125, 0xffff0000, v75
    v_fmac_f32 v116, v102, v124
    v_fmac_f32 v117, v102, v125
    s_waitcnt vmcnt(4)
    v_lshlrev_b32 v124, 16, v76
    v_and_b32 v125, 0xffff0000, v76
    v_fmac_f32 v110, v103, v124
    v_fmac_f32 v111, v103, v125
    v_lshlrev_b32 v124, 16, v77
    v_and_b32 v125, 0xffff0000, v77
    v_fmac_f32 v112, v103, v124
    v_fmac_f32 v113, v103, v125
    v_lshlrev_b32 v124, 16, v78
    v_and_b32 v125, 0xffff0000, v78
    v_fmac_f32 v114, v103, v124
    v_fmac_f32 v115, v103, v125
    v_lshlrev_b32 v124, 16, v79
    v_and_b32 v125, 0xffff0000, v79
    v_fmac_f32 v116, v103, v124
    v_fmac_f32 v117, v103, v125
    s_waitcnt vmcnt(3)
    v_lshlrev_b32 v124, 16, v80
    v_and_b32 v125, 0xffff0000, v80
    v_fmac_f32 v110, v104, v124
    v_fmac_f32 v111, v104, v125
    v_lshlrev_b32 v124, 16, v81
    v_and_b32 v125, 0xffff0000, v81
    v_fmac_f32 v112, v104, v124
    v_fmac_f32 v113, v104, v125
    v_lshlrev_b32 v124, 16, v82
    v_and_b32 v125, 0xffff0000, v82
    v_fmac_f32 v114, v104, v124
    v_fmac_f32 v115, v104, v125
    v_lshlrev_b32 v124, 16, v83
    v_and_b32 v125, 0xffff0000, v83
    v_fmac_f32 v116, v104, v124
    v_fmac_f32 v117, v104, v125
    s_waitcnt vmcnt(2)
    v_lshlrev_b32 v124, 16, v84
    v_and_b32 v125, 0xffff0000, v84
    v_fmac_f32 v110, v105, v124
    v_fmac_f32 v111, v105, v125
    v_lshlrev_b32 v124, 16, v85
    v_and_b32 v125, 0xffff0000, v85
    v_fmac_f32 v112, v105, v124
    v_fmac_f32 v113, v105, v125
    v_lshlrev_b32 v124, 16, v86
    v_and_b32 v125, 0xffff0000, v86
    v_fmac_f32 v114, v105, v124
    v_fmac_f32 v115, v105, v125
    v_lshlrev_b32 v124, 16, v87
    v_and_b32 v125, 0xffff0000, v87
    v_fmac_f32 v116, v105, v124
    v_fmac_f32 v117, v105, v125
    s_waitcnt vmcnt(1)
    v_lshlrev_b32 v124, 16, v88
    v_and_b32 v125, 0xffff0000, v88
    v_fmac_f32 v110, v106, v124
    v_fmac_f32 v111, v106, v125
    v_lshlrev_b32 v124, 16, v89
    v_and_b32 v125, 0xffff0000, v89
    v_fmac_f32 v112, v106, v124
    v_fmac_f32 v113, v106, v125
    v_lshlrev_b32 v124, 16, v90
    v_and_b32 v125, 0xffff0000, v90
    v_fmac_f32 v114, v106, v124
    v_fmac_f32 v115, v106, v125
    v_lshlrev_b32 v124, 16, v91
    v_and_b32 v125, 0xffff0000, v91
    v_fmac_f32 v116, v106, v124
    v_fmac_f32 v117, v106, v125
    s_waitcnt vmcnt(0)
    v_lshlrev_b32 v124, 16, v92
    v_and_b32 v125, 0xffff0000, v92
    v_fmac_f32 v110, v107, v124
    v_fmac_f32 v111, v107, v125
    v_lshlrev_b32 v124, 16, v93
    v_and_b32 v125, 0xffff0000, v93
    v_fmac_f32 v112, v107, v124
    v_fmac_f32 v113, v107, v125
    v_lshlrev_b32 v124, 16, v94
    v_and_b32 v125, 0xffff0000, v94
    v_fmac_f32 v114, v107, v124
    v_fmac_f32 v115, v107, v125
    v_lshlrev_b32 v124, 16, v95
    v_and_b32 v125, 0xffff0000, v95
    v_fmac_f32 v116, v107, v124
    v_fmac_f32 v117, v107, v125
    v_cvt_pk_bf16_f32 v128, v110, v111
    v_cvt_pk_bf16_f32 v129, v112, v113
    v_cvt_pk_bf16_f32 v130, v114, v115
    v_cvt_pk_bf16_f32 v131, v116, v117
    ds_write_b64 v121, v[128:129]
    ds_write_b64 v121, v[130:131] offset:32
    ds_read_b128 v[132:135], v122
    s_waitcnt lgkmcnt(0)
    buffer_store_dwordx4 v[132:135], v120, s[64:67], s29 offen
DONE:
    s_endpgm
OWN:
    v_add_u32 v228, 131072, v228
    v_add_u32 v229, 131072, v229
    v_add_u32 v230, 131072, v230
    v_add_u32 v231, 131072, v231
    ds_read_b128 v[144:147], v228 offset:0
    ds_read_b128 v[148:151], v229 offset:0
    ds_read_b128 v[152:155], v230 offset:0
    ds_read_b128 v[156:159], v231 offset:0
    ds_read_b128 v[160:163], v228 offset:4096
    ds_read_b128 v[164:167], v229 offset:4096
    ds_read_b128 v[168:171], v230 offset:4096
    ds_read_b128 v[172:175], v231 offset:4096
    v_and_b32 v242, 15, v249
    v_lshrrev_b32 v243, 4, v249
    v_lshlrev_b32 v243, 3, v243
    v_lshl_add_u32 v242, v242, 6, v243
    v_add_u32 v242, 147456, v242
    ds_read_b64 v[96:97], v242 offset:0
    ds_read_b64 v[98:99], v242 offset:32
    ds_read_b64 v[100:101], v242 offset:1024
    ds_read_b64 v[102:103], v242 offset:1056
    v_add_u32 v232, 73728, v232
    v_add_u32 v233, 73728, v233
    v_add_u32 v234, 73728, v234
    v_add_u32 v235, 73728, v235
    v_add_u32 v236, 73728, v236
    v_add_u32 v237, 73728, v237
    v_add_u32 v238, 73728, v238
    v_add_u32 v239, 73728, v239
    v_mov_b32 v246, 0xceabfb8f
    v_mfma_f32_16x16x32_bf16 v[0:3], v[176:179], v[104:107], v[0:3]
    s_waitcnt lgkmcnt(3)
    v_lshlrev_b32 v64, 16, v96
    v_sub_f32 v64, 1.0, v64
    v_fma_f32 v64, v64, v246, v208
    v_mfma_f32_16x16x32_bf16 v[4:7], v[176:179], v[108:111], v[4:7]
    v_and_b32 v65, 0xffff0000, v96
    v_sub_f32 v65, 1.0, v65
    v_fma_f32 v65, v65, v246, v208
    ds_read_b64_tr_b16 v[176:177], v232 offset:0
    ds_read_b64_tr_b16 v[178:179], v232 offset:4096
    v_mfma_f32_16x16x32_bf16 v[8:11], v[180:183], v[104:107], v[8:11]
    v_lshlrev_b32 v66, 16, v97
    v_sub_f32 v66, 1.0, v66
    v_fma_f32 v66, v66, v246, v208
    v_mfma_f32_16x16x32_bf16 v[12:15], v[180:183], v[108:111], v[12:15]
    v_and_b32 v67, 0xffff0000, v97
    v_sub_f32 v67, 1.0, v67
    v_fma_f32 v67, v67, v246, v208
    ds_read_b64_tr_b16 v[180:181], v233 offset:0
    ds_read_b64_tr_b16 v[182:183], v233 offset:4096
    v_mfma_f32_16x16x32_bf16 v[16:19], v[184:187], v[104:107], v[16:19]
    s_waitcnt lgkmcnt(6)
    v_lshlrev_b32 v72, 16, v98
    v_sub_f32 v72, 1.0, v72
    v_fma_f32 v72, v72, v246, v208
    v_mfma_f32_16x16x32_bf16 v[20:23], v[184:187], v[108:111], v[20:23]
    v_and_b32 v73, 0xffff0000, v98
    v_sub_f32 v73, 1.0, v73
    v_fma_f32 v73, v73, v246, v208
    ds_read_b64_tr_b16 v[184:185], v234 offset:0
    ds_read_b64_tr_b16 v[186:187], v234 offset:4096
    v_mfma_f32_16x16x32_bf16 v[24:27], v[188:191], v[104:107], v[24:27]
    v_lshlrev_b32 v74, 16, v99
    v_sub_f32 v74, 1.0, v74
    v_fma_f32 v74, v74, v246, v208
    v_mfma_f32_16x16x32_bf16 v[28:31], v[188:191], v[108:111], v[28:31]
    v_and_b32 v75, 0xffff0000, v99
    v_sub_f32 v75, 1.0, v75
    v_fma_f32 v75, v75, v246, v208
    ds_read_b64_tr_b16 v[188:189], v235 offset:0
    ds_read_b64_tr_b16 v[190:191], v235 offset:4096
    v_mfma_f32_16x16x32_bf16 v[32:35], v[192:195], v[104:107], v[32:35]
    s_waitcnt lgkmcnt(9)
    v_lshlrev_b32 v68, 16, v100
    v_sub_f32 v68, 1.0, v68
    v_fma_f32 v68, v68, v246, v212
    v_mfma_f32_16x16x32_bf16 v[36:39], v[192:195], v[108:111], v[36:39]
    v_and_b32 v69, 0xffff0000, v100
    v_sub_f32 v69, 1.0, v69
    v_fma_f32 v69, v69, v246, v212
    ds_read_b64_tr_b16 v[192:193], v236 offset:0
    ds_read_b64_tr_b16 v[194:195], v236 offset:4096
    v_mfma_f32_16x16x32_bf16 v[40:43], v[196:199], v[104:107], v[40:43]
    v_lshlrev_b32 v70, 16, v101
    v_sub_f32 v70, 1.0, v70
    v_fma_f32 v70, v70, v246, v212
    v_mfma_f32_16x16x32_bf16 v[44:47], v[196:199], v[108:111], v[44:47]
    v_and_b32 v71, 0xffff0000, v101
    v_sub_f32 v71, 1.0, v71
    v_fma_f32 v71, v71, v246, v212
    ds_read_b64_tr_b16 v[196:197], v237 offset:0
    ds_read_b64_tr_b16 v[198:199], v237 offset:4096
    v_mfma_f32_16x16x32_bf16 v[48:51], v[200:203], v[104:107], v[48:51]
    s_waitcnt lgkmcnt(12)
    v_lshlrev_b32 v76, 16, v102
    v_sub_f32 v76, 1.0, v76
    v_fma_f32 v76, v76, v246, v212
    v_mfma_f32_16x16x32_bf16 v[52:55], v[200:203], v[108:111], v[52:55]
    v_and_b32 v77, 0xffff0000, v102
    v_sub_f32 v77, 1.0, v77
    v_fma_f32 v77, v77, v246, v212
    ds_read_b64_tr_b16 v[200:201], v238 offset:0
    ds_read_b64_tr_b16 v[202:203], v238 offset:4096
    v_mfma_f32_16x16x32_bf16 v[56:59], v[204:207], v[104:107], v[56:59]
    v_lshlrev_b32 v78, 16, v103
    v_sub_f32 v78, 1.0, v78
    v_fma_f32 v78, v78, v246, v212
    v_mfma_f32_16x16x32_bf16 v[60:63], v[204:207], v[108:111], v[60:63]
    v_and_b32 v79, 0xffff0000, v103
    v_sub_f32 v79, 1.0, v79
    v_fma_f32 v79, v79, v246, v212
    ds_read_b64_tr_b16 v[204:205], v239 offset:0
    ds_read_b64_tr_b16 v[206:207], v239 offset:4096
    v_mfma_f32_16x16x32_bf16 v[216:219], v[224:227], v[104:107], v[216:219]
    v_mfma_f32_16x16x32_bf16 v[220:223], v[224:227], v[108:111], v[220:223]
    v_mfma_f32_16x16x32_bf16 v[64:67], v[144:147], v[112:115], v[64:67]
    v_mfma_f32_16x16x32_bf16 v[64:67], v[148:151], v[116:119], v[64:67]
    v_mfma_f32_16x16x32_bf16 v[64:67], v[152:155], v[120:123], v[64:67]
    v_mfma_f32_16x16x32_bf16 v[64:67], v[156:159], v[124:127], v[64:67]
    v_mfma_f32_16x16x32_bf16 v[72:75], v[160:163], v[112:115], v[72:75]
    v_mfma_f32_16x16x32_bf16 v[72:75], v[164:167], v[116:119], v[72:75]
    v_mfma_f32_16x16x32_bf16 v[72:75], v[168:171], v[120:123], v[72:75]
    v_mfma_f32_16x16x32_bf16 v[72:75], v[172:175], v[124:127], v[72:75]
    v_mfma_f32_16x16x32_bf16 v[68:71], v[144:147], v[128:131], v[68:71]
    v_mfma_f32_16x16x32_bf16 v[68:71], v[148:151], v[132:135], v[68:71]
    v_mfma_f32_16x16x32_bf16 v[68:71], v[152:155], v[136:139], v[68:71]
    v_mfma_f32_16x16x32_bf16 v[68:71], v[156:159], v[140:143], v[68:71]
    v_mfma_f32_16x16x32_bf16 v[76:79], v[160:163], v[128:131], v[76:79]
    v_mfma_f32_16x16x32_bf16 v[76:79], v[164:167], v[132:135], v[76:79]
    v_mfma_f32_16x16x32_bf16 v[76:79], v[168:171], v[136:139], v[76:79]
    v_mfma_f32_16x16x32_bf16 v[76:79], v[172:175], v[140:143], v[76:79]
    v_exp_f32 v242, v64
    v_exp_f32 v243, v65
    v_exp_f32 v244, v66
    v_exp_f32 v245, v67
    v_cvt_pk_bf16_f32 v96, v242, v243
    v_exp_f32 v246, v72
    v_exp_f32 v247, v73
    v_cvt_pk_bf16_f32 v97, v244, v245
    v_exp_f32 v242, v74
    v_exp_f32 v243, v75
    v_cvt_pk_bf16_f32 v98, v246, v247
    v_or3_b32 v248, v96, v97, v98
    v_exp_f32 v244, v68
    v_exp_f32 v245, v69
    v_cvt_pk_bf16_f32 v99, v242, v243
    v_exp_f32 v246, v70
    v_exp_f32 v247, v71
    v_cvt_pk_bf16_f32 v100, v244, v245
    v_or3_b32 v248, v248, v99, v100
    v_exp_f32 v242, v76
    v_exp_f32 v243, v77
    v_cvt_pk_bf16_f32 v101, v246, v247
    v_exp_f32 v244, v78
    v_exp_f32 v245, v79
    v_cvt_pk_bf16_f32 v102, v242, v243
    v_or3_b32 v248, v248, v101, v102
    v_cvt_pk_bf16_f32 v103, v244, v245
    v_or_b32 v248, v248, v103
    v_and_b32 v248, 0x40004000, v248
    v_cmp_ne_u32 vcc, 0, v248
    s_cbranch_vccnz TR_T
BK_T:
    s_waitcnt lgkmcnt(14)
    v_mfma_f32_16x16x32_bf16 v[0:3], v[176:179], v[96:99], v[0:3]
    v_mfma_f32_16x16x32_bf16 v[4:7], v[176:179], v[100:103], v[4:7]
    s_waitcnt lgkmcnt(12)
    v_mfma_f32_16x16x32_bf16 v[8:11], v[180:183], v[96:99], v[8:11]
    v_mfma_f32_16x16x32_bf16 v[12:15], v[180:183], v[100:103], v[12:15]
    s_waitcnt lgkmcnt(10)
    v_mfma_f32_16x16x32_bf16 v[16:19], v[184:187], v[96:99], v[16:19]
    v_mfma_f32_16x16x32_bf16 v[20:23], v[184:187], v[100:103], v[20:23]
    s_waitcnt lgkmcnt(8)
    v_mfma_f32_16x16x32_bf16 v[24:27], v[188:191], v[96:99], v[24:27]
    v_mfma_f32_16x16x32_bf16 v[28:31], v[188:191], v[100:103], v[28:31]
    s_waitcnt lgkmcnt(6)
    v_mfma_f32_16x16x32_bf16 v[32:35], v[192:195], v[96:99], v[32:35]
    v_mfma_f32_16x16x32_bf16 v[36:39], v[192:195], v[100:103], v[36:39]
    s_waitcnt lgkmcnt(4)
    v_mfma_f32_16x16x32_bf16 v[40:43], v[196:199], v[96:99], v[40:43]
    v_mfma_f32_16x16x32_bf16 v[44:47], v[196:199], v[100:103], v[44:47]
    s_waitcnt lgkmcnt(2)
    v_mfma_f32_16x16x32_bf16 v[48:51], v[200:203], v[96:99], v[48:51]
    v_mfma_f32_16x16x32_bf16 v[52:55], v[200:203], v[100:103], v[52:55]
    s_waitcnt lgkmcnt(0)
    v_mfma_f32_16x16x32_bf16 v[56:59], v[204:207], v[96:99], v[56:59]
    v_mfma_f32_16x16x32_bf16 v[60:63], v[204:207], v[100:103], v[60:63]
    v_mfma_f32_16x16x32_bf16 v[216:219], v[224:227], v[96:99], v[216:219]
    v_mfma_f32_16x16x32_bf16 v[220:223], v[224:227], v[100:103], v[220:223]
    v_lshlrev_b32 v242, 4, v249
    v_add_u32 v243, 131072, v242
    v_cvt_pk_bf16_f32 v112, v0, v1
    v_cvt_pk_bf16_f32 v113, v2, v3
    v_cvt_pk_bf16_f32 v114, v8, v9
    v_cvt_pk_bf16_f32 v115, v10, v11
    ds_write_b128 v243, v[112:115] offset:0
    v_cvt_pk_bf16_f32 v116, v16, v17
    v_cvt_pk_bf16_f32 v117, v18, v19
    v_cvt_pk_bf16_f32 v118, v24, v25
    v_cvt_pk_bf16_f32 v119, v26, v27
    ds_write_b128 v243, v[116:119] offset:1024
    v_cvt_pk_bf16_f32 v120, v32, v33
    v_cvt_pk_bf16_f32 v121, v34, v35
    v_cvt_pk_bf16_f32 v122, v40, v41
    v_cvt_pk_bf16_f32 v123, v42, v43
    ds_write_b128 v243, v[120:123] offset:2048
    v_cvt_pk_bf16_f32 v124, v48, v49
    v_cvt_pk_bf16_f32 v125, v50, v51
    v_cvt_pk_bf16_f32 v126, v56, v57
    v_cvt_pk_bf16_f32 v127, v58, v59
    ds_write_b128 v243, v[124:127] offset:3072
    v_cvt_pk_bf16_f32 v128, v4, v5
    v_cvt_pk_bf16_f32 v129, v6, v7
    v_cvt_pk_bf16_f32 v130, v12, v13
    v_cvt_pk_bf16_f32 v131, v14, v15
    ds_write_b128 v243, v[128:131] offset:4096
    v_cvt_pk_bf16_f32 v132, v20, v21
    v_cvt_pk_bf16_f32 v133, v22, v23
    v_cvt_pk_bf16_f32 v134, v28, v29
    v_cvt_pk_bf16_f32 v135, v30, v31
    ds_write_b128 v243, v[132:135] offset:5120
    v_cvt_pk_bf16_f32 v136, v36, v37
    v_cvt_pk_bf16_f32 v137, v38, v39
    v_cvt_pk_bf16_f32 v138, v44, v45
    v_cvt_pk_bf16_f32 v139, v46, v47
    ds_write_b128 v243, v[136:139] offset:6144
    v_cvt_pk_bf16_f32 v140, v52, v53
    v_cvt_pk_bf16_f32 v141, v54, v55
    v_cvt_pk_bf16_f32 v142, v60, v61
    v_cvt_pk_bf16_f32 v143, v62, v63
    ds_write_b128 v243, v[140:143] offset:7168
    v_lshrrev_b32 v152, 4, v249
    v_subrev_u32 v153, s23, v152
    v_add_u32 v154, 4, v153
    v_and_b32 v153, 7, v153
    v_and_b32 v154, 7, v154
    v_cmp_eq_u32 s[44:45], 0, v153
    v_cmp_eq_u32 s[46:47], 0, v154
    s_mov_b32 s30, 131072
    s_mov_b32 s29, 0xbf800000
POLL:
    buffer_load_dwordx4 v[144:147], v242, s[76:79], 0 offen sc1
    buffer_load_dwordx4 v[148:151], v242, s[76:79], 0 offen offset:1024 sc1
    s_waitcnt vmcnt(0)
    v_cndmask_b32 v144, v144, v208, s[44:45]
    v_cndmask_b32 v148, v148, v208, s[46:47]
    v_cndmask_b32 v145, v145, v216, s[44:45]
    v_cndmask_b32 v149, v149, v216, s[46:47]
    v_cndmask_b32 v146, v146, v212, s[44:45]
    v_cndmask_b32 v150, v150, v212, s[46:47]
    v_cndmask_b32 v147, v147, v220, s[44:45]
    v_cndmask_b32 v151, v151, v220, s[46:47]
    v_cmp_eq_u32 vcc, s29, v145
    v_cmp_eq_u32 s[48:49], s29, v149
    s_nop 0
    s_or_b64 vcc, vcc, s[48:49]
    s_cbranch_vccz POLLED
    s_sub_u32 s30, s30, 1
    s_cbranch_scc1 POLLED
    s_sleep 2
    s_branch POLL
POLLED:
    s_waitcnt lgkmcnt(0)
    s_barrier
    s_lshl_b32 s29, s24, 10
    s_lshl_b32 s28, s23, 16
    v_lshlrev_b32 v123, 4, v249
    v_add_u32 v123, s29, v123
    v_add_u32 v120, s28, v123
    s_lshl_b32 s28, s23, 13
    s_add_u32 s28, s28, 8192
    s_and_b32 s28, s28, 0xffff
    buffer_load_dwordx4 v[68:71], v120, s[56:59], s28 offen sc1
    s_add_u32 s28, s28, 8192
    s_and_b32 s28, s28, 0xffff
    buffer_load_dwordx4 v[72:75], v120, s[56:59], s28 offen sc1
    s_add_u32 s28, s28, 8192
    s_and_b32 s28, s28, 0xffff
    buffer_load_dwordx4 v[76:79], v120, s[56:59], s28 offen sc1
    s_add_u32 s28, s28, 8192
    s_and_b32 s28, s28, 0xffff
    buffer_load_dwordx4 v[80:83], v120, s[56:59], s28 offen sc1
    s_add_u32 s28, s28, 8192
    s_and_b32 s28, s28, 0xffff
    buffer_load_dwordx4 v[84:87], v120, s[56:59], s28 offen sc1
    s_add_u32 s28, s28, 8192
    s_and_b32 s28, s28, 0xffff
    buffer_load_dwordx4 v[88:91], v120, s[56:59], s28 offen sc1
    s_add_u32 s28, s28, 8192
    s_and_b32 s28, s28, 0xffff
    buffer_load_dwordx4 v[92:95], v120, s[56:59], s28 offen sc1
    v_add_u32 v123, 131072, v123
    ds_read_b128 v[64:67], v123
    v_and_b32 v152, 15, v249
    v_lshlrev_b32 v152, 5, v152
    v_add_u32 v152, 140288, v152
    v_lshl_add_u32 v153, v153, 2, v152
    v_lshl_add_u32 v154, v154, 2, v152
    v_min_f32 v156, v144, v148
    v_mov_b32 v157, v156
    s_nop 1
    v_permlane32_swap_b32 v156, v157
    v_min_f32 v156, v156, v157
    v_mov_b32 v157, v156
    s_nop 1
    v_permlane16_swap_b32 v156, v157
    v_min_f32 v156, v156, v157
    v_sub_f32 v144, v156, v144
    v_sub_f32 v148, v156, v148
    v_exp_f32 v144, v144
    v_exp_f32 v148, v148
    v_mul_f32 v158, v144, v145
    v_fmac_f32 v158, v148, v149
    v_mov_b32 v157, v158
    s_nop 1
    v_permlane32_swap_b32 v158, v157
    v_add_f32 v158, v158, v157
    v_mov_b32 v157, v158
    s_nop 1
    v_permlane16_swap_b32 v158, v157
    v_add_f32 v158, v158, v157
    v_rcp_f32 v158, v158
    s_nop 0
    v_mul_f32 v144, v144, v158
    v_mul_f32 v148, v148, v158
    ds_write_b32 v153, v144 offset:0
    ds_write_b32 v154, v148 offset:0
    v_min_f32 v156, v146, v150
    v_mov_b32 v157, v156
    s_nop 1
    v_permlane32_swap_b32 v156, v157
    v_min_f32 v156, v156, v157
    v_mov_b32 v157, v156
    s_nop 1
    v_permlane16_swap_b32 v156, v157
    v_min_f32 v156, v156, v157
    v_sub_f32 v146, v156, v146
    v_sub_f32 v150, v156, v150
    v_exp_f32 v146, v146
    v_exp_f32 v150, v150
    v_mul_f32 v158, v146, v147
    v_fmac_f32 v158, v150, v151
    v_mov_b32 v157, v158
    s_nop 1
    v_permlane32_swap_b32 v158, v157
    v_add_f32 v158, v158, v157
    v_mov_b32 v157, v158
    s_nop 1
    v_permlane16_swap_b32 v158, v157
    v_add_f32 v158, v158, v157
    v_rcp_f32 v158, v158
    s_nop 0
    v_mul_f32 v146, v146, v158
    v_mul_f32 v150, v150, v158
    ds_write_b32 v153, v146 offset:512
    ds_write_b32 v154, v150 offset:512
    s_branch COMB
TR_0:
    s_call_b64 s[98:99], RARE_0
    s_branch BK_0
TR_1:
    s_call_b64 s[98:99], RARE_1
    s_branch BK_1
TR_2:
    s_call_b64 s[98:99], RARE_0
    s_branch BK_2
TR_3:
    s_call_b64 s[98:99], RARE_1
    s_branch BK_3
TR_4:
    s_call_b64 s[98:99], RARE_0
    s_branch BK_4
TR_5:
    s_call_b64 s[98:99], RARE_1
    s_branch BK_5
TR_6:
    s_call_b64 s[98:99], RARE_0
    s_branch BK_6
TR_7:
    s_call_b64 s[98:99], RARE_1
    s_branch BK_7
TR_8:
    s_call_b64 s[98:99], RARE_0
    s_branch BK_8
TR_9:
    s_call_b64 s[98:99], RARE_1
    s_branch BK_9
TR_10:
    s_call_b64 s[98:99], RARE_0
    s_branch BK_10
TR_11:
    s_call_b64 s[98:99], RARE_1
    s_branch BK_11
TR_12:
    s_call_b64 s[98:99], RARE_0
    s_branch BK_12
TR_13:
    s_call_b64 s[98:99], RARE_1
    s_branch BK_13
TR_14:
    s_call_b64 s[98:99], RARE_0
    s_branch BK_14
TR_15:
    s_call_b64 s[98:99], RARE_1
    s_branch BK_15
TR_16:
    s_call_b64 s[98:99], RARE_0
    s_branch BK_16
TR_17:
    s_call_b64 s[98:99], RARE_1
    s_branch BK_17
TR_18:
    s_call_b64 s[98:99], RARE_0
    s_branch BK_18
TR_19:
    s_call_b64 s[98:99], RARE_1
    s_branch BK_19
TR_20:
    s_call_b64 s[98:99], RARE_0
    s_branch BK_20
TR_21:
    s_call_b64 s[98:99], RARE_1
    s_branch BK_21
TR_22:
    s_call_b64 s[98:99], RARE_0
    s_branch BK_22
TR_23:
    s_call_b64 s[98:99], RARE_1
    s_branch BK_23
TR_24:
    s_call_b64 s[98:99], RARE_0
    s_branch BK_24
TR_25:
    s_call_b64 s[98:99], RARE_1
    s_branch BK_25
TR_26:
    s_call_b64 s[98:99], RARE_0
    s_branch BK_26
TR_27:
    s_call_b64 s[98:99], RARE_1
    s_branch BK_27
TR_28:
    s_call_b64 s[98:99], RARE_0
    s_branch BK_28
TR_29:
    s_call_b64 s[98:99], RARE_1
    s_branch BK_29
TR_30:
    s_call_b64 s[98:99], RARE_0
    s_branch BK_30
TR_31:
    s_call_b64 s[98:99], RARE_1
    s_branch BK_31
TR_T:
    s_call_b64 s[98:99], RARE_0
    s_branch BK_T
RARE_0:
    s_nop 15
    v_max3_f32 v250, v64, v65, v66
    v_max3_f32 v251, v67, v72, v73
    v_max3_f32 v250, v250, v74, v75
    v_max_f32 v250, v250, v251
    v_mov_b32 v251, v250
    s_nop 1
    v_permlane32_swap_b32 v250, v251
    v_max_f32 v250, v250, v251
    v_mov_b32 v251, v250
    s_nop 1
    v_permlane16_swap_b32 v250, v251
    v_max_f32 v250, v250, v251
    v_add_f32 v250, 0x41000000, v250
    v_max_f32 v250, 0, v250
    v_exp_f32 v251, -v250
    v_sub_f32 v64, v64, v250
    v_sub_f32 v65, v65, v250
    v_sub_f32 v66, v66, v250
    v_sub_f32 v67, v67, v250
    v_sub_f32 v72, v72, v250
    v_sub_f32 v73, v73, v250
    v_sub_f32 v74, v74, v250
    v_sub_f32 v75, v75, v250
    v_sub_f32 v80, v80, v250
    v_sub_f32 v81, v81, v250
    v_sub_f32 v82, v82, v250
    v_sub_f32 v83, v83, v250
    v_sub_f32 v88, v88, v250
    v_sub_f32 v89, v89, v250
    v_sub_f32 v90, v90, v250
    v_sub_f32 v91, v91, v250
    v_sub_f32 v208, v208, v250
    v_sub_f32 v209, v209, v250
    v_sub_f32 v210, v210, v250
    v_sub_f32 v211, v211, v250
    v_mul_f32 v216, v216, v251
    v_mul_f32 v217, v217, v251
    v_mul_f32 v218, v218, v251
    v_mul_f32 v219, v219, v251
    v_mul_f32 v0, v0, v251
    v_mul_f32 v1, v1, v251
    v_mul_f32 v2, v2, v251
    v_mul_f32 v3, v3, v251
    v_mul_f32 v8, v8, v251
    v_mul_f32 v9, v9, v251
    v_mul_f32 v10, v10, v251
    v_mul_f32 v11, v11, v251
    v_mul_f32 v16, v16, v251
    v_mul_f32 v17, v17, v251
    v_mul_f32 v18, v18, v251
    v_mul_f32 v19, v19, v251
    v_mul_f32 v24, v24, v251
    v_mul_f32 v25, v25, v251
    v_mul_f32 v26, v26, v251
    v_mul_f32 v27, v27, v251
    v_mul_f32 v32, v32, v251
    v_mul_f32 v33, v33, v251
    v_mul_f32 v34, v34, v251
    v_mul_f32 v35, v35, v251
    v_mul_f32 v40, v40, v251
    v_mul_f32 v41, v41, v251
    v_mul_f32 v42, v42, v251
    v_mul_f32 v43, v43, v251
    v_mul_f32 v48, v48, v251
    v_mul_f32 v49, v49, v251
    v_mul_f32 v50, v50, v251
    v_mul_f32 v51, v51, v251
    v_mul_f32 v56, v56, v251
    v_mul_f32 v57, v57, v251
    v_mul_f32 v58, v58, v251
    v_mul_f32 v59, v59, v251
    v_max3_f32 v252, v68, v69, v70
    v_max3_f32 v253, v71, v76, v77
    v_max3_f32 v252, v252, v78, v79
    v_max_f32 v252, v252, v253
    v_mov_b32 v253, v252
    s_nop 1
    v_permlane32_swap_b32 v252, v253
    v_max_f32 v252, v252, v253
    v_mov_b32 v253, v252
    s_nop 1
    v_permlane16_swap_b32 v252, v253
    v_max_f32 v252, v252, v253
    v_add_f32 v252, 0x41000000, v252
    v_max_f32 v252, 0, v252
    v_exp_f32 v253, -v252
    v_sub_f32 v68, v68, v252
    v_sub_f32 v69, v69, v252
    v_sub_f32 v70, v70, v252
    v_sub_f32 v71, v71, v252
    v_sub_f32 v76, v76, v252
    v_sub_f32 v77, v77, v252
    v_sub_f32 v78, v78, v252
    v_sub_f32 v79, v79, v252
    v_sub_f32 v84, v84, v252
    v_sub_f32 v85, v85, v252
    v_sub_f32 v86, v86, v252
    v_sub_f32 v87, v87, v252
    v_sub_f32 v92, v92, v252
    v_sub_f32 v93, v93, v252
    v_sub_f32 v94, v94, v252
    v_sub_f32 v95, v95, v252
    v_sub_f32 v212, v212, v252
    v_sub_f32 v213, v213, v252
    v_sub_f32 v214, v214, v252
    v_sub_f32 v215, v215, v252
    v_mul_f32 v220, v220, v253
    v_mul_f32 v221, v221, v253
    v_mul_f32 v222, v222, v253
    v_mul_f32 v223, v223, v253
    v_mul_f32 v4, v4, v253
    v_mul_f32 v5, v5, v253
    v_mul_f32 v6, v6, v253
    v_mul_f32 v7, v7, v253
    v_mul_f32 v12, v12, v253
    v_mul_f32 v13, v13, v253
    v_mul_f32 v14, v14, v253
    v_mul_f32 v15, v15, v253
    v_mul_f32 v20, v20, v253
    v_mul_f32 v21, v21, v253
    v_mul_f32 v22, v22, v253
    v_mul_f32 v23, v23, v253
    v_mul_f32 v28, v28, v253
    v_mul_f32 v29, v29, v253
    v_mul_f32 v30, v30, v253
    v_mul_f32 v31, v31, v253
    v_mul_f32 v36, v36, v253
    v_mul_f32 v37, v37, v253
    v_mul_f32 v38, v38, v253
    v_mul_f32 v39, v39, v253
    v_mul_f32 v44, v44, v253
    v_mul_f32 v45, v45, v253
    v_mul_f32 v46, v46, v253
    v_mul_f32 v47, v47, v253
    v_mul_f32 v52, v52, v253
    v_mul_f32 v53, v53, v253
    v_mul_f32 v54, v54, v253
    v_mul_f32 v55, v55, v253
    v_mul_f32 v60, v60, v253
    v_mul_f32 v61, v61, v253
    v_mul_f32 v62, v62, v253
    v_mul_f32 v63, v63, v253
    v_exp_f32 v242, v64
    v_exp_f32 v243, v65
    v_exp_f32 v244, v66
    v_exp_f32 v245, v67
    v_cvt_pk_bf16_f32 v96, v242, v243
    v_exp_f32 v246, v72
    v_exp_f32 v247, v73
    v_cvt_pk_bf16_f32 v97, v244, v245
    v_exp_f32 v242, v74
    v_exp_f32 v243, v75
    v_cvt_pk_bf16_f32 v98, v246, v247
    v_exp_f32 v244, v68
    v_exp_f32 v245, v69
    v_cvt_pk_bf16_f32 v99, v242, v243
    v_exp_f32 v246, v70
    v_exp_f32 v247, v71
    v_cvt_pk_bf16_f32 v100, v244, v245
    v_exp_f32 v242, v76
    v_exp_f32 v243, v77
    v_cvt_pk_bf16_f32 v101, v246, v247
    v_exp_f32 v244, v78
    v_exp_f32 v245, v79
    v_cvt_pk_bf16_f32 v102, v242, v243
    v_cvt_pk_bf16_f32 v103, v244, v245
    s_nop 1
    s_setpc_b64 s[98:99]
RARE_1:
    s_nop 15
    v_max3_f32 v250, v80, v81, v82
    v_max3_f32 v251, v83, v88, v89
    v_max3_f32 v250, v250, v90, v91
    v_max_f32 v250, v250, v251
    v_mov_b32 v251, v250
    s_nop 1
    v_permlane32_swap_b32 v250, v251
    v_max_f32 v250, v250, v251
    v_mov_b32 v251, v250
    s_nop 1
    v_permlane16_swap_b32 v250, v251
    v_max_f32 v250, v250, v251
    v_add_f32 v250, 0x41000000, v250
    v_max_f32 v250, 0, v250
    v_exp_f32 v251, -v250
    v_sub_f32 v64, v64, v250
    v_sub_f32 v65, v65, v250
    v_sub_f32 v66, v66, v250
    v_sub_f32 v67, v67, v250
    v_sub_f32 v72, v72, v250
    v_sub_f32 v73, v73, v250
    v_sub_f32 v74, v74, v250
    v_sub_f32 v75, v75, v250
    v_sub_f32 v80, v80, v250
    v_sub_f32 v81, v81, v250
    v_sub_f32 v82, v82, v250
    v_sub_f32 v83, v83, v250
    v_sub_f32 v88, v88, v250
    v_sub_f32 v89, v89, v250
    v_sub_f32 v90, v90, v250
    v_sub_f32 v91, v91, v250
    v_sub_f32 v208, v208, v250
    v_sub_f32 v209, v209, v250
    v_sub_f32 v210, v210, v250
    v_sub_f32 v211, v211, v250
    v_mul_f32 v216, v216, v251
    v_mul_f32 v217, v217, v251
    v_mul_f32 v218, v218, v251
    v_mul_f32 v219, v219, v251
    v_mul_f32 v0, v0, v251
    v_mul_f32 v1, v1, v251
    v_mul_f32 v2, v2, v251
    v_mul_f32 v3, v3, v251
    v_mul_f32 v8, v8, v251
    v_mul_f32 v9, v9, v251
    v_mul_f32 v10, v10, v251
    v_mul_f32 v11, v11, v251
    v_mul_f32 v16, v16, v251
    v_mul_f32 v17, v17, v251
    v_mul_f32 v18, v18, v251
    v_mul_f32 v19, v19, v251
    v_mul_f32 v24, v24, v251
    v_mul_f32 v25, v25, v251
    v_mul_f32 v26, v26, v251
    v_mul_f32 v27, v27, v251
    v_mul_f32 v32, v32, v251
    v_mul_f32 v33, v33, v251
    v_mul_f32 v34, v34, v251
    v_mul_f32 v35, v35, v251
    v_mul_f32 v40, v40, v251
    v_mul_f32 v41, v41, v251
    v_mul_f32 v42, v42, v251
    v_mul_f32 v43, v43, v251
    v_mul_f32 v48, v48, v251
    v_mul_f32 v49, v49, v251
    v_mul_f32 v50, v50, v251
    v_mul_f32 v51, v51, v251
    v_mul_f32 v56, v56, v251
    v_mul_f32 v57, v57, v251
    v_mul_f32 v58, v58, v251
    v_mul_f32 v59, v59, v251
    v_max3_f32 v252, v84, v85, v86
    v_max3_f32 v253, v87, v92, v93
    v_max3_f32 v252, v252, v94, v95
    v_max_f32 v252, v252, v253
    v_mov_b32 v253, v252
    s_nop 1
    v_permlane32_swap_b32 v252, v253
    v_max_f32 v252, v252, v253
    v_mov_b32 v253, v252
    s_nop 1
    v_permlane16_swap_b32 v252, v253
    v_max_f32 v252, v252, v253
    v_add_f32 v252, 0x41000000, v252
    v_max_f32 v252, 0, v252
    v_exp_f32 v253, -v252
    v_sub_f32 v68, v68, v252
    v_sub_f32 v69, v69, v252
    v_sub_f32 v70, v70, v252
    v_sub_f32 v71, v71, v252
    v_sub_f32 v76, v76, v252
    v_sub_f32 v77, v77, v252
    v_sub_f32 v78, v78, v252
    v_sub_f32 v79, v79, v252
    v_sub_f32 v84, v84, v252
    v_sub_f32 v85, v85, v252
    v_sub_f32 v86, v86, v252
    v_sub_f32 v87, v87, v252
    v_sub_f32 v92, v92, v252
    v_sub_f32 v93, v93, v252
    v_sub_f32 v94, v94, v252
    v_sub_f32 v95, v95, v252
    v_sub_f32 v212, v212, v252
    v_sub_f32 v213, v213, v252
    v_sub_f32 v214, v214, v252
    v_sub_f32 v215, v215, v252
    v_mul_f32 v220, v220, v253
    v_mul_f32 v221, v221, v253
    v_mul_f32 v222, v222, v253
    v_mul_f32 v223, v223, v253
    v_mul_f32 v4, v4, v253
    v_mul_f32 v5, v5, v253
    v_mul_f32 v6, v6, v253
    v_mul_f32 v7, v7, v253
    v_mul_f32 v12, v12, v253
    v_mul_f32 v13, v13, v253
    v_mul_f32 v14, v14, v253
    v_mul_f32 v15, v15, v253
    v_mul_f32 v20, v20, v253
    v_mul_f32 v21, v21, v253
    v_mul_f32 v22, v22, v253
    v_mul_f32 v23, v23, v253
    v_mul_f32 v28, v28, v253
    v_mul_f32 v29, v29, v253
    v_mul_f32 v30, v30, v253
    v_mul_f32 v31, v31, v253
    v_mul_f32 v36, v36, v253
    v_mul_f32 v37, v37, v253
    v_mul_f32 v38, v38, v253
    v_mul_f32 v39, v39, v253
    v_mul_f32 v44, v44, v253
    v_mul_f32 v45, v45, v253
    v_mul_f32 v46, v46, v253
    v_mul_f32 v47, v47, v253
    v_mul_f32 v52, v52, v253
    v_mul_f32 v53, v53, v253
    v_mul_f32 v54, v54, v253
    v_mul_f32 v55, v55, v253
    v_mul_f32 v60, v60, v253
    v_mul_f32 v61, v61, v253
    v_mul_f32 v62, v62, v253
    v_mul_f32 v63, v63, v253
    v_exp_f32 v242, v80
    v_exp_f32 v243, v81
    v_exp_f32 v244, v82
    v_exp_f32 v245, v83
    v_cvt_pk_bf16_f32 v104, v242, v243
    v_exp_f32 v246, v88
    v_exp_f32 v247, v89
    v_cvt_pk_bf16_f32 v105, v244, v245
    v_exp_f32 v242, v90
    v_exp_f32 v243, v91
    v_cvt_pk_bf16_f32 v106, v246, v247
    v_exp_f32 v244, v84
    v_exp_f32 v245, v85
    v_cvt_pk_bf16_f32 v107, v242, v243
    v_exp_f32 v246, v86
    v_exp_f32 v247, v87
    v_cvt_pk_bf16_f32 v108, v244, v245
    v_exp_f32 v242, v92
    v_exp_f32 v243, v93
    v_cvt_pk_bf16_f32 v109, v246, v247
    v_exp_f32 v244, v94
    v_exp_f32 v245, v95
    v_cvt_pk_bf16_f32 v110, v242, v243
    v_cvt_pk_bf16_f32 v111, v244, v245
    s_nop 1
    s_setpc_b64 s[98:99]
CODE_END:
.section .rodata,"a"
.p2align 6
.amdhsa_kernel standalone__tree_speculative_verify_tree_attention_over_candidate_token_tree__sampling_kernel
  .amdhsa_next_free_vgpr 256
  .amdhsa_next_free_sgpr 100
  .amdhsa_accum_offset 256
  .amdhsa_group_segment_fixed_size 0
  .amdhsa_kernarg_size 72
  .amdhsa_user_sgpr_count 2
  .amdhsa_user_sgpr_kernarg_segment_ptr 1
  .amdhsa_system_sgpr_workgroup_id_x 1
.end_amdhsa_kernel
```
